```python
import torch

def _softmax(x, axis=-1):
    return torch.softmax(x, dim=axis)
def _gelu(x):
    return torch.nn.functional.gelu(x, approximate="tanh")
def _silu(x):
    return torch.nn.functional.silu(x)
def _sigmoid(x):
    return torch.sigmoid(x)
def _layernorm(x, axis=-1, eps=1e-5):
    m = x.mean(dim=axis, keepdim=True)
    v = x.var(dim=axis, keepdim=True, unbiased=False)
    return (x - m) / torch.sqrt(v + eps)
def _scatter_add(tgt, idx, src, axis=0):
    return tgt.clone().index_add_(axis, idx, src)
def _segment_sum(src, seg, n):
    out = torch.zeros((n,) + src.shape[1:], dtype=src.dtype)
    return out.index_add_(0, seg, src)
def _pad(x, pw):
    flat = tuple(v for pair in reversed(pw) for v in pair)
    return torch.nn.functional.pad(x, flat)

kernel_name = 'gather_scatter__edge_featured_mpnn_egc__graph'

def setup_inputs():

    _w = (lambda a: (lambda t: t.to(torch.bfloat16) if t.is_floating_point() else t)(torch.as_tensor(a)))
    N, deg, D, De = 12500, 64, 64, max(16, 1)
    E = N * deg
    return {
        "x": _w((lambda *s: torch.randn(*s, dtype=torch.bfloat16) * 0.2)(N, D)),
        "e_attr": _w((lambda *s: torch.randn(*s, dtype=torch.bfloat16) * 0.2)(E, De)),
        "src": _w((lambda lo, hi, *s: torch.randint(lo, hi, s))(0, N, E).to(torch.int64)),
        "dst": _w((lambda lo, hi, *s: torch.randint(lo, hi, s))(0, N, E).to(torch.int64)),
        "u_w": _w((lambda *s: torch.randn(*s, dtype=torch.bfloat16) * 0.05)(D, D)),
        "v_w": _w((lambda *s: torch.randn(*s, dtype=torch.bfloat16) * 0.05)(D, D)),
        "g_w": _w((lambda *s: torch.randn(*s, dtype=torch.bfloat16) * 0.2)(2 * D + De, D)),
    }

def reference(x, e_attr, src, dst, u_w, v_w, g_w):
    N, D = x.shape
    g_in = torch.concatenate([x[dst], x[src], e_attr], axis=-1)
    eta = _sigmoid(g_in @ g_w)
    hv = x @ v_w
    msg = eta * hv[src]
    agg = _segment_sum(msg, dst, N)
    return _silu(x @ u_w + agg)
```

```asm
; @launch kernel=part_kernel grid=(263,1,1) block=(512,1,1) lds=14848
; @launch kernel=gather_scatter__edge_featured_mpnn_egc__graph_kernel grid=(256,1,1) block=(512,1,1) lds=158720
.amdgcn_target "amdgcn-amd-amdhsa--gfx950"
.text
    .globl part_kernel
    .p2align 8
    .type part_kernel,@function
part_kernel:
    s_load_dwordx4 s[4:7], s[0:1], 16
    s_load_dwordx2 s[24:25], s[0:1], 72
    s_cmp_ge_u32 s2, 255
    s_cbranch_scc1 P_CPW
    v_lshrrev_b32 v3, 6, v0
    v_lshlrev_b32 v1, 2, v0
    v_readfirstlane_b32 s28, v3
    s_cmp_ge_u32 s2, 250
    s_cbranch_scc1 P_PREP
    v_mov_b32 v2, 0
    ds_write_b32 v1, v2
    v_lshlrev_b32 v4, 4, v0
    v_lshlrev_b32 v5, 3, v0
    v_add_u32 v5, 8192, v5
    v_add_u32 v6, 12288, v1
    s_mul_i32 s29, s2, 12800
    s_waitcnt lgkmcnt(0)
    s_mov_b32 s12, s6
    s_mov_b32 s13, s7
    s_mov_b32 s14, 3200000
    s_mov_b32 s15, 0x20000
    s_cmp_ge_u32 s28, 2
    s_cbranch_scc1 P_NO6A
    buffer_load_dword v14, v6, s[12:15], s29 offen
P_NO6A:
    buffer_load_dwordx4 v[8:11], v4, s[12:15], s29 offen
    buffer_load_dwordx2 v[12:13], v5, s[12:15], s29 offen
    s_mov_b32 s8, s4
    s_mov_b32 s9, s5
    s_mov_b32 s10, 3200000
    s_mov_b32 s11, 0x20000
    s_mov_b32 s16, s24
    s_mov_b32 s17, s25
    s_mov_b32 s18, 4194304
    s_mov_b32 s19, 0x20000
    v_lshlrev_b32 v56, 16, v0
    v_lshlrev_b32 v57, 15, v0
    v_add_u32 v57, 33554432, v57
    v_lshlrev_b32 v58, 14, v0
    v_add_u32 v58, 50331648, v58
    v_mov_b32 v59, 1
    s_mov_b32 s32, 4294967247
    s_mov_b32 s33, 16384
    s_mov_b32 s34, 32768
    s_mov_b32 s35, 49152
    s_barrier
    s_cmp_ge_u32 s28, 2
    s_cselect_b32 s37, 0x40000000, 0
    v_or_b32 v6, s37, v6
    buffer_load_dwordx4 v[16:19], v4, s[8:11], s29 offen
    buffer_load_dwordx2 v[20:21], v5, s[8:11], s29 offen
    buffer_load_dword v22, v6, s[8:11], s29 offen
    s_waitcnt vmcnt(3)
    v_mul_u32_u24 v24, 21400, v8
    v_lshrrev_b32 v24, 20, v24
    v_mad_i32_i24 v40, v24, s32, v8
    v_lshlrev_b32 v24, 2, v24
    ds_add_rtn_u32 v32, v24, v59
    v_mul_u32_u24 v25, 21400, v9
    v_lshrrev_b32 v25, 20, v25
    v_mad_i32_i24 v41, v25, s32, v9
    v_lshlrev_b32 v25, 2, v25
    ds_add_rtn_u32 v33, v25, v59
    v_mul_u32_u24 v26, 21400, v10
    v_lshrrev_b32 v26, 20, v26
    v_mad_i32_i24 v42, v26, s32, v10
    v_lshlrev_b32 v26, 2, v26
    ds_add_rtn_u32 v34, v26, v59
    v_mul_u32_u24 v27, 21400, v11
    v_lshrrev_b32 v27, 20, v27
    v_mad_i32_i24 v43, v27, s32, v11
    v_lshlrev_b32 v27, 2, v27
    ds_add_rtn_u32 v35, v27, v59
    v_mul_u32_u24 v28, 21400, v12
    v_lshrrev_b32 v28, 20, v28
    v_mad_i32_i24 v44, v28, s32, v12
    v_lshlrev_b32 v28, 2, v28
    ds_add_rtn_u32 v36, v28, v59
    v_mul_u32_u24 v29, 21400, v13
    v_lshrrev_b32 v29, 20, v29
    v_mad_i32_i24 v45, v29, s32, v13
    v_lshlrev_b32 v29, 2, v29
    ds_add_rtn_u32 v37, v29, v59
    s_cmp_ge_u32 s28, 2
    s_cbranch_scc1 P_NO6B
    v_mul_u32_u24 v30, 21400, v14
    v_lshrrev_b32 v30, 20, v30
    v_mad_i32_i24 v46, v30, s32, v14
    v_lshlrev_b32 v30, 2, v30
    ds_add_rtn_u32 v38, v30, v59
P_NO6B:
    v_and_b32 v60, 63, v0
    v_lshlrev_b32 v60, 4, v60
    s_waitcnt lgkmcnt(0)
    s_barrier
    ds_read_b128 v[64:67], v60
    s_waitcnt lgkmcnt(0)
    v_add_u32 v69, v64, v65
    v_add_u32 v70, v69, v66
    v_add_u32 v71, v70, v67
    v_mov_b32 v72, v71
    s_nop 1
    v_add_u32_dpp v72, v72, v72 row_shr:1 row_mask:0xf bank_mask:0xf bound_ctrl:1
    s_nop 1
    v_add_u32_dpp v72, v72, v72 row_shr:2 row_mask:0xf bank_mask:0xf bound_ctrl:1
    s_nop 1
    v_add_u32_dpp v72, v72, v72 row_shr:4 row_mask:0xf bank_mask:0xf bound_ctrl:1
    s_nop 1
    v_add_u32_dpp v72, v72, v72 row_shr:8 row_mask:0xf bank_mask:0xf bound_ctrl:1
    s_nop 1
    v_add_u32_dpp v72, v72, v72 row_bcast:15 row_mask:0xa bank_mask:0xf
    s_nop 1
    v_add_u32_dpp v72, v72, v72 row_bcast:31 row_mask:0xc bank_mask:0xf
    v_sub_u32 v68, v72, v71
    v_add_u32 v71, v68, v70
    v_add_u32 v70, v68, v69
    v_add_u32 v69, v68, v64
    ds_write_b128 v60, v[68:71] offset:1024
    ds_read_b32 v8, v24 offset:1024
    ds_read_b32 v9, v25 offset:1024
    ds_read_b32 v10, v26 offset:1024
    ds_read_b32 v11, v27 offset:1024
    ds_read_b32 v12, v28 offset:1024
    ds_read_b32 v13, v29 offset:1024
    s_waitcnt vmcnt(0)
    s_cmp_lg_u32 s28, 4
    s_cbranch_scc1 P_NOOFF
    v_lshl_or_b32 v64, v64, 16, v68
    v_lshl_or_b32 v65, v65, 16, v69
    v_lshl_or_b32 v66, v66, 16, v70
    v_lshl_or_b32 v67, v67, 16, v71
    v_lshrrev_b32 v61, 6, v60
    v_lshlrev_b32 v61, 14, v61
    v_and_b32 v62, 63, v60
    v_or_b32 v61, v61, v62
    s_lshl_b32 s36, s2, 6
    s_add_u32 s36, s36, 3200000
    buffer_store_dwordx4 v[64:67], v61, s[16:19], s36 offen sc1
P_NOOFF:
    v_lshl_or_b32 v40, v40, 26, v16
    v_add3_u32 v40, v40, v56, 0
    v_lshl_or_b32 v41, v41, 26, v17
    v_add3_u32 v41, v41, v56, s33
    v_lshl_or_b32 v42, v42, 26, v18
    v_add3_u32 v42, v42, v56, s34
    v_lshl_or_b32 v43, v43, 26, v19
    v_add3_u32 v43, v43, v56, s35
    v_lshl_or_b32 v44, v44, 26, v20
    v_add3_u32 v44, v44, v57, 0
    v_lshl_or_b32 v45, v45, 26, v21
    v_add3_u32 v45, v45, v57, s33
    v_lshl_or_b32 v46, v46, 26, v22
    v_add3_u32 v46, v46, v58, 0
    s_cmp_ge_u32 s28, 2
    s_cbranch_scc1 P_NO6C
    ds_read_b32 v14, v30 offset:1024
    s_waitcnt lgkmcnt(0)
    v_add_lshl_u32 v38, v38, v14, 2
    ds_write_b32 v38, v46 offset:2048
P_NO6C:
    s_waitcnt lgkmcnt(0)
    v_add_lshl_u32 v32, v32, v8, 2
    ds_write_b32 v32, v40 offset:2048
    v_add_lshl_u32 v33, v33, v9, 2
    ds_write_b32 v33, v41 offset:2048
    v_add_lshl_u32 v34, v34, v10, 2
    ds_write_b32 v34, v42 offset:2048
    v_add_lshl_u32 v35, v35, v11, 2
    ds_write_b32 v35, v43 offset:2048
    v_add_lshl_u32 v36, v36, v12, 2
    ds_write_b32 v36, v44 offset:2048
    v_add_lshl_u32 v37, v37, v13, 2
    ds_write_b32 v37, v45 offset:2048
    s_waitcnt lgkmcnt(0)
    s_barrier
    ds_read_b128 v[8:11], v4 offset:2048
    v_cmp_gt_u32 vcc, 288, v0
    s_and_saveexec_b64 s[38:39], vcc
    ds_read_b128 v[12:15], v4 offset:10240
    s_mov_b64 exec, s[38:39]
    s_waitcnt lgkmcnt(0)
    buffer_store_dwordx4 v[8:11], v4, s[16:19], s29 offen sc1
    s_add_u32 s36, s29, 8192
    s_and_saveexec_b64 s[38:39], vcc
    s_cbranch_execz P_FIN
    buffer_store_dwordx4 v[12:15], v4, s[16:19], s36 offen sc1
P_FIN:
    s_endpgm
P_PREP:
    s_load_dwordx4 s[8:11], s[0:1], 32
    s_load_dwordx2 s[12:13], s[0:1], 48
    s_sub_u32 s30, s2, 250
    s_lshl_b32 s30, s30, 3
    s_add_u32 s30, s30, s28
    s_waitcnt lgkmcnt(0)
    s_cmp_ge_u32 s30, 34
    s_cbranch_scc1 P_END
    s_mov_b32 s20, s12
    s_mov_b32 s21, s13
    s_mov_b32 s22, 18432
    s_mov_b32 s23, 0x20000
    s_mov_b32 s33, 3216550459
    s_mov_b32 s31, s30
    s_mov_b32 s32, 64
    s_cmp_lt_u32 s30, 8
    s_cbranch_scc1 P_GO
    s_cmp_lt_u32 s30, 16
    s_cbranch_scc0 P_C1
    s_sub_u32 s31, s30, 8
    s_mov_b32 s32, 0
    s_mov_b32 s33, 1.0
    s_mov_b32 s20, s10
    s_mov_b32 s21, s11
    s_mov_b32 s22, 8192
    s_branch P_GO
P_C1:
    s_cmp_lt_u32 s30, 18
    s_cbranch_scc0 P_C2
    s_sub_u32 s31, s30, 16
    s_lshl_b32 s31, s31, 2
    s_mov_b32 s32, 128
    s_branch P_GO
P_C2:
    s_mov_b32 s33, 1.0
    s_mov_b32 s32, 0
    s_sub_u32 s31, s30, 18
    s_cmp_lt_u32 s30, 26
    s_cbranch_scc1 P_GO
    s_sub_u32 s31, s30, 26
    s_mov_b32 s20, s8
    s_mov_b32 s21, s9
    s_mov_b32 s22, 8192
P_GO:
    s_and_b32 s34, s31, 3
    s_lshl_b32 s34, s34, 4
    s_add_u32 s34, s34, s32
    s_lshl_b32 s34, s34, 7
    s_lshr_b32 s35, s31, 2
    s_lshl_b32 s35, s35, 6
    s_add_u32 s34, s34, s35
    v_and_b32 v1, 31, v0
    v_lshlrev_b32 v1, 1, v1
    v_bfe_u32 v2, v0, 5, 1
    v_lshl_or_b32 v1, v2, 10, v1
    buffer_load_ushort v8, v1, s[20:23], s34 offen offset:0
    buffer_load_ushort v9, v1, s[20:23], s34 offen offset:128
    buffer_load_ushort v10, v1, s[20:23], s34 offen offset:256
    buffer_load_ushort v11, v1, s[20:23], s34 offen offset:384
    buffer_load_ushort v12, v1, s[20:23], s34 offen offset:512
    buffer_load_ushort v13, v1, s[20:23], s34 offen offset:640
    buffer_load_ushort v14, v1, s[20:23], s34 offen offset:768
    buffer_load_ushort v15, v1, s[20:23], s34 offen offset:896
    s_mov_b32 s16, s24
    s_mov_b32 s17, s25
    s_mov_b32 s18, 4194304
    s_mov_b32 s19, 0x20000
    v_and_b32 v3, 63, v0
    v_lshlrev_b32 v3, 4, v3
    s_lshl_b32 s36, s30, 10
    s_add_u32 s36, s36, 3670016
    s_waitcnt vmcnt(0)
    v_lshlrev_b32 v8, 16, v8
    v_mul_f32 v8, s33, v8
    v_lshlrev_b32 v9, 16, v9
    v_mul_f32 v9, s33, v9
    v_lshlrev_b32 v10, 16, v10
    v_mul_f32 v10, s33, v10
    v_lshlrev_b32 v11, 16, v11
    v_mul_f32 v11, s33, v11
    v_lshlrev_b32 v12, 16, v12
    v_mul_f32 v12, s33, v12
    v_lshlrev_b32 v13, 16, v13
    v_mul_f32 v13, s33, v13
    v_lshlrev_b32 v14, 16, v14
    v_mul_f32 v14, s33, v14
    v_lshlrev_b32 v15, 16, v15
    v_mul_f32 v15, s33, v15
    v_cvt_pk_bf16_f32 v16, v8, v9
    v_cvt_pk_bf16_f32 v17, v10, v11
    v_cvt_pk_bf16_f32 v18, v12, v13
    v_cvt_pk_bf16_f32 v19, v14, v15
    buffer_store_dwordx4 v[16:19], v3, s[16:19], s36 offen sc1
P_END:
    s_endpgm
P_CPW:
    s_cmp_ge_u32 s2, 263
    s_cbranch_scc1 P_END
    s_getpc_b64 s[40:41]
P_PC:
    s_add_u32 s40, s40, gather_scatter__edge_featured_mpnn_egc__graph_kernel-P_PC
    s_addc_u32 s41, s41, 0
    v_lshlrev_b32 v2, 7, v0
    v_cmp_gt_u32 vcc, M_CODE_END-gather_scatter__edge_featured_mpnn_egc__graph_kernel, v2
    s_and_saveexec_b64 s[42:43], vcc
    s_cbranch_execz P_END
    global_load_dword v3, v2, s[40:41]
    s_endpgm
    .globl gather_scatter__edge_featured_mpnn_egc__graph_kernel
    .p2align 8
    .type gather_scatter__edge_featured_mpnn_egc__graph_kernel,@function
gather_scatter__edge_featured_mpnn_egc__graph_kernel:
    s_load_dwordx2 s[26:27], s[0:1], 72
    s_load_dwordx4 s[4:7], s[0:1], 0
    s_load_dwordx2 s[24:25], s[0:1], 56
    s_cmp_ge_u32 s2, 256
    s_cbranch_scc1 M_END
    v_lshrrev_b32 v1, 6, v0
    v_and_b32 v2, 63, v0
    v_readfirstlane_b32 s28, v1
    s_and_b32 s50, s2, 7
    s_lshl_b32 s50, s50, 5
    s_lshr_b32 s38, s2, 3
    s_add_u32 s50, s50, s38
    s_mul_i32 s64, s38, 50048
    v_lshrrev_b32 v3, 1, v0
    v_min_u32 v3, 249, v3
    v_lshlrev_b32 v192, 6, v3
    v_lshlrev_b32 v193, 4, v2
    s_lshr_b32 s34, s50, 4
    s_lshl_b32 s34, s34, 12
    s_and_b32 s38, s50, 15
    s_add_u32 s34, s34, s38
    s_lshl_b32 s34, s34, 2
    s_add_u32 s34, s34, 3200000
    s_mov_b32 s18, 4194304
    s_mov_b32 s19, 0x20000
    s_lshr_b32 s38, s28, 2
    s_lshl_b32 s38, s38, 13
    s_and_b32 s39, s28, 3
    s_lshl_b32 s39, s39, 10
    s_add_u32 s60, s38, s39
    s_lshl_b32 s62, s28, 10
    s_add_u32 s62, s62, 3670016
    v_lshlrev_b32 v209, 4, v0
    v_add_u32 v209, 130048, v209
    v_mov_b64 v[164:165], 0
    v_mov_b64 v[166:167], 0
    s_cmp_lg_u32 s28, 0
    ds_write_b128 v209, v[164:167]
    ds_write_b128 v209, v[164:167] offset:8192
    ds_write_b128 v209, v[164:167] offset:16384
    s_cbranch_scc1 M_NOZ3
    ds_write_b128 v209, v[164:167] offset:24576
M_NOZ3:
    v_and_b32 v210, 127, v0
    v_lshlrev_b32 v210, 2, v210
    v_mov_b32 v211, 0
    ds_write_b32 v210, v211
    s_waitcnt lgkmcnt(0)
    s_mov_b32 s16, s26
    s_mov_b32 s17, s27
    s_add_u32 m0, s60, 1024
    buffer_load_dword v212, v192, s[16:19], s34 offen
    s_add_u32 s38, s62, 18432
    buffer_load_dwordx4 v193, s[16:19], s38 offen lds
    s_add_u32 m0, s60, 17408
    s_add_u32 s38, s62, 26624
    buffer_load_dwordx4 v193, s[16:19], s38 offen lds
    v_lshrrev_b32 v194, 4, v2
    s_lshl_b32 s38, s28, 2
    v_add_u32 v194, s38, v194
    v_xor_b32 v194, v194, v2
    v_and_b32 v194, 7, v194
    v_lshlrev_b32 v194, 4, v194
    v_lshrrev_b32 v195, 3, v2
    v_lshl_or_b32 v194, v195, 7, v194
    s_mov_b32 s8, s4
    s_mov_b32 s9, s5
    s_mov_b32 s10, 1600000
    s_mov_b32 s11, 0x20000
    s_cmp_ge_u32 s28, 7
    s_cbranch_scc1 M_NOROW
    s_lshl_b32 s38, s28, 10
    s_mul_i32 s39, s50, 6272
    s_add_u32 m0, s60, 33792
    s_add_u32 s39, s39, s38
    buffer_load_dwordx4 v194, s[8:11], s39 offen lds
M_NOROW:
    s_add_u32 s48, s26, s34
    s_addc_u32 s49, s27, 0
    v_cmp_gt_u32 vcc, 500, v0
    v_mul_u32_u24 v210, 3200, v3
    v_and_b32 v211, 1, v0
    v_lshlrev_b32 v211, 2, v211
    v_min_u32 v1, 390, v0
    v_lshlrev_b32 v1, 7, v1
    s_waitcnt vmcnt(2)
M_RW3:
    v_cndmask_b32 v212, 0, v212, vcc
    v_and_b32 v209, 0xffff, v212
    v_lshrrev_b32 v212, 16, v212
    v_add3_u32 v209, v209, v210, v211
    v_cmp_lt_u32 s[46:47], 40, v212
    v_sub_u32 v212, v212, v211
    v_lshlrev_b32 v213, 5, v210
    v_lshlrev_b32 v209, 2, v209
    v_cmp_lt_i32 vcc, 16, v212
    v_cmp_lt_i32 s[52:53], 24, v212
    v_cmp_lt_i32 s[54:55], 32, v212
    buffer_load_dwordx4 v[76:79], v209, s[16:19], 0 offen
    buffer_load_dwordx4 v[80:83], v209, s[16:19], 0 offen offset:32
    s_or_b64 vcc, vcc, 1
    s_mov_b64 exec, vcc
    buffer_load_dwordx4 v[84:87], v209, s[16:19], 0 offen offset:64
    s_mov_b32 s51, 0
    s_mov_b64 exec, s[52:53]
    s_cbranch_execz M_RL3
    s_mov_b32 s51, 1
    buffer_load_dwordx4 v[88:91], v209, s[16:19], 0 offen offset:96
    s_mov_b64 exec, s[54:55]
    s_cbranch_execz M_RL3
    s_mov_b32 s51, 3
    buffer_load_dwordx4 v[92:95], v209, s[16:19], 0 offen offset:128
M_RL3:
    s_mov_b64 exec, -1
    s_mov_b32 s12, s6
    s_mov_b32 s13, s7
    s_mov_b32 s14, 25600000
    s_mov_b32 s15, 0x20000
    s_mov_b32 s20, s24
    s_mov_b32 s21, s25
    s_mov_b32 s22, 1600000
    s_mov_b32 s23, 0x20000
    s_lshr_b32 s38, s28, 2
    s_lshl_b32 s38, s38, 1
    s_and_b32 s39, s28, 1
    s_add_u32 s38, s38, s39
    s_lshl_b32 s38, s38, 13
    s_add_u32 s38, s38, 1024
    v_add_u32 v194, s38, v193
    v_and_b32 v210, 31, v2
    v_lshlrev_b32 v208, 2, v210
    v_add_u32 v208, 115712, v208
    v_lshrrev_b32 v211, 5, v2
    v_bfe_u32 v192, v2, 1, 3
    v_xor_b32 v192, v192, v211
    s_bfe_u32 s42, s28, 0x10001
    s_lshl_b32 s39, s42, 13
    s_add_u32 s38, s39, 33792
    v_lshlrev_b32 v210, 7, v210
    v_add_u32 v210, s38, v210
    s_and_b32 s34, s28, 1
    s_lshl_b32 s34, s34, 7
    s_add_u32 s39, s39, s34
    v_lshlrev_b32 v211, 10, v211
    v_add3_u32 v218, v211, v208, s39
    s_mov_b32 s34, 3216550459
    v_xor_b32 v220, 0, v192
    v_lshl_add_u32 v220, v220, 4, v210
    v_xor_b32 v221, 2, v192
    v_lshl_add_u32 v221, v221, 4, v210
    v_xor_b32 v222, 4, v192
    v_lshl_add_u32 v222, v222, 4, v210
    v_xor_b32 v223, 6, v192
    v_lshl_add_u32 v223, v223, 4, v210
    v_mov_b32 v214, 1
    v_mov_b32 v219, 0xfc
    v_cmp_lt_i32 s[68:69], 0, v212
    v_cmp_lt_i32 s[70:71], 1, v212
    v_cmp_lt_i32 s[72:73], 2, v212
    v_cmp_lt_i32 s[74:75], 3, v212
    v_cmp_lt_i32 s[76:77], 8, v212
    v_cmp_lt_i32 s[78:79], 9, v212
    v_cmp_lt_i32 s[80:81], 10, v212
    v_cmp_lt_i32 s[82:83], 11, v212
    v_cmp_lt_i32 s[84:85], 16, v212
    v_cmp_lt_i32 s[86:87], 17, v212
    v_cmp_lt_i32 s[88:89], 18, v212
    v_cmp_lt_i32 s[90:91], 19, v212
    s_cmp_eq_u32 s51, 0
    s_waitcnt vmcnt(4)
    s_cbranch_scc0 M_BA
    s_waitcnt vmcnt(3)
M_BA:
    s_barrier
    ds_read_b128 v[168:171], v194 offset:0
    ds_read_b128 v[152:155], v220
    ds_read_b128 v[172:175], v194 offset:1024
    ds_read_b128 v[156:159], v221
    ds_read_b128 v[176:179], v194 offset:2048
    ds_read_b128 v[160:163], v222
    ds_read_b128 v[180:183], v194 offset:3072
    ds_read_b128 v[164:167], v223
    s_cmp_eq_u64 s[46:47], 0
    s_cbranch_scc1 M_NOFLAG
    v_mov_b32 v210, 256
    ds_write_b32 v210, v214
M_NOFLAG:
    s_waitcnt lgkmcnt(0)
    v_mfma_f32_32x32x16_bf16 v[136:151], v[152:155], v[168:171], 0
    v_mfma_f32_32x32x16_bf16 v[136:151], v[156:159], v[172:175], v[136:151]
    v_mfma_f32_32x32x16_bf16 v[136:151], v[160:163], v[176:179], v[136:151]
    v_mfma_f32_32x32x16_bf16 v[136:151], v[164:167], v[180:183], v[136:151]
    s_mov_b32 s37, 2097024
    s_mov_b32 s44, 1.0
    s_mov_b32 s45, 1.0
    s_mov_b32 s40, 0
    s_lshl_b32 s35, s28, 13
    s_add_u32 s35, s35, 1024
    s_lshl_b32 s36, s28, 11
    s_add_u32 s36, s36, 66560
    s_nop 3
    s_cmp_ge_u32 s28, 4
    s_cbranch_scc1 M_ADONE
    v_mul_f32 v136, s34, v136
    ds_write_b32 v218, v136 offset:0
    v_mul_f32 v137, s34, v137
    ds_write_b32 v218, v137 offset:256
    v_mul_f32 v138, s34, v138
    ds_write_b32 v218, v138 offset:512
    v_mul_f32 v139, s34, v139
    ds_write_b32 v218, v139 offset:768
    v_mul_f32 v140, s34, v140
    ds_write_b32 v218, v140 offset:2048
    v_mul_f32 v141, s34, v141
    ds_write_b32 v218, v141 offset:2304
    v_mul_f32 v142, s34, v142
    ds_write_b32 v218, v142 offset:2560
    v_mul_f32 v143, s34, v143
    ds_write_b32 v218, v143 offset:2816
    v_mul_f32 v144, s34, v144
    ds_write_b32 v218, v144 offset:4096
    v_mul_f32 v145, s34, v145
    ds_write_b32 v218, v145 offset:4352
    v_mul_f32 v146, s34, v146
    ds_write_b32 v218, v146 offset:4608
    v_mul_f32 v147, s34, v147
    ds_write_b32 v218, v147 offset:4864
    s_cmp_lg_u32 s42, 0
    s_cbranch_scc1 M_ADONE
    v_mul_f32 v148, s34, v148
    ds_write_b32 v218, v148 offset:6144
    v_mul_f32 v149, s34, v149
    ds_write_b32 v218, v149 offset:6400
    v_mul_f32 v150, s34, v150
    ds_write_b32 v218, v150 offset:6656
    v_mul_f32 v151, s34, v151
    ds_write_b32 v218, v151 offset:6912
M_ADONE:
    s_waitcnt vmcnt(0)
    v_and_b32_sdwa v116, v219, v76 dst_sel:DWORD dst_unused:UNUSED_PAD src0_sel:DWORD src1_sel:BYTE_3
    v_and_b32_sdwa v117, v219, v77 dst_sel:DWORD dst_unused:UNUSED_PAD src0_sel:DWORD src1_sel:BYTE_3
    v_and_b32_sdwa v118, v219, v78 dst_sel:DWORD dst_unused:UNUSED_PAD src0_sel:DWORD src1_sel:BYTE_3
    v_and_b32_sdwa v119, v219, v79 dst_sel:DWORD dst_unused:UNUSED_PAD src0_sel:DWORD src1_sel:BYTE_3
    v_and_b32_sdwa v120, v219, v80 dst_sel:DWORD dst_unused:UNUSED_PAD src0_sel:DWORD src1_sel:BYTE_3
    v_and_b32_sdwa v121, v219, v81 dst_sel:DWORD dst_unused:UNUSED_PAD src0_sel:DWORD src1_sel:BYTE_3
    v_and_b32_sdwa v122, v219, v82 dst_sel:DWORD dst_unused:UNUSED_PAD src0_sel:DWORD src1_sel:BYTE_3
    v_and_b32_sdwa v123, v219, v83 dst_sel:DWORD dst_unused:UNUSED_PAD src0_sel:DWORD src1_sel:BYTE_3
    v_and_b32_sdwa v124, v219, v84 dst_sel:DWORD dst_unused:UNUSED_PAD src0_sel:DWORD src1_sel:BYTE_3
    v_and_b32_sdwa v125, v219, v85 dst_sel:DWORD dst_unused:UNUSED_PAD src0_sel:DWORD src1_sel:BYTE_3
    v_and_b32_sdwa v126, v219, v86 dst_sel:DWORD dst_unused:UNUSED_PAD src0_sel:DWORD src1_sel:BYTE_3
    v_and_b32_sdwa v127, v219, v87 dst_sel:DWORD dst_unused:UNUSED_PAD src0_sel:DWORD src1_sel:BYTE_3
    s_mov_b64 exec, s[68:69]
    ds_add_rtn_u32 v96, v116, v214
    s_mov_b64 exec, s[70:71]
    ds_add_rtn_u32 v97, v117, v214
    s_mov_b64 exec, s[72:73]
    ds_add_rtn_u32 v98, v118, v214
    s_mov_b64 exec, s[74:75]
    ds_add_rtn_u32 v99, v119, v214
    s_mov_b64 exec, s[76:77]
    ds_add_rtn_u32 v100, v120, v214
    s_mov_b64 exec, s[78:79]
    ds_add_rtn_u32 v101, v121, v214
    s_mov_b64 exec, s[80:81]
    ds_add_rtn_u32 v102, v122, v214
    s_mov_b64 exec, s[82:83]
    ds_add_rtn_u32 v103, v123, v214
    s_mov_b64 exec, s[84:85]
    ds_add_rtn_u32 v104, v124, v214
    s_mov_b64 exec, s[86:87]
    ds_add_rtn_u32 v105, v125, v214
    s_mov_b64 exec, s[88:89]
    ds_add_rtn_u32 v106, v126, v214
    s_mov_b64 exec, s[90:91]
    ds_add_rtn_u32 v107, v127, v214
    s_mov_b64 exec, -1
    s_add_u32 m0, s60, 37888
    s_add_u32 s38, s62, 8192
    buffer_load_dwordx4 v193, s[16:19], s62 offen lds
    s_add_u32 m0, s60, 54272
    s_cmp_ge_u32 s28, 2
    buffer_load_dwordx4 v193, s[16:19], s38 offen lds
    s_cbranch_scc1 M_NOW4
    s_add_u32 m0, s36, 9216
    s_add_u32 s38, s62, 16384
    buffer_load_dwordx4 v193, s[16:19], s38 offen lds
M_NOW4:
    buffer_load_dword v1, v1, s[8:11], s64 offen
    v_bfe_u32 v220, v76, 14, 12
    v_lshl_add_u32 v220, v220, 5, v213
    v_alignbit_b32 v76, v76, v76, 25
    v_bfe_u32 v221, v77, 14, 12
    v_lshl_add_u32 v221, v221, 5, v213
    v_alignbit_b32 v77, v77, v77, 25
    v_bfe_u32 v222, v78, 14, 12
    v_lshl_add_u32 v222, v222, 5, v213
    v_alignbit_b32 v78, v78, v78, 25
    v_bfe_u32 v223, v79, 14, 12
    v_lshl_add_u32 v223, v223, 5, v213
    v_alignbit_b32 v79, v79, v79, 25
    v_bfe_u32 v224, v80, 14, 12
    v_lshl_add_u32 v224, v224, 5, v213
    v_alignbit_b32 v80, v80, v80, 25
    v_bfe_u32 v225, v81, 14, 12
    v_lshl_add_u32 v225, v225, 5, v213
    v_alignbit_b32 v81, v81, v81, 25
    v_bfe_u32 v226, v82, 14, 12
    v_lshl_add_u32 v226, v226, 5, v213
    v_alignbit_b32 v82, v82, v82, 25
    v_bfe_u32 v227, v83, 14, 12
    v_lshl_add_u32 v227, v227, 5, v213
    v_alignbit_b32 v83, v83, v83, 25
    v_bfe_u32 v228, v84, 14, 12
    v_lshl_add_u32 v228, v228, 5, v213
    v_alignbit_b32 v84, v84, v84, 25
    v_bfe_u32 v229, v85, 14, 12
    v_lshl_add_u32 v229, v229, 5, v213
    v_alignbit_b32 v85, v85, v85, 25
    v_bfe_u32 v230, v86, 14, 12
    v_lshl_add_u32 v230, v230, 5, v213
    v_alignbit_b32 v86, v86, v86, 25
    v_bfe_u32 v231, v87, 14, 12
    v_lshl_add_u32 v231, v231, 5, v213
    v_alignbit_b32 v87, v87, v87, 25
    s_cmp_eq_u32 s51, 0
    s_cbranch_scc1 M_RAR
    v_cmp_lt_i32 s[92:93], 24, v212
    v_cmp_lt_i32 s[94:95], 25, v212
    v_cmp_lt_i32 s[96:97], 26, v212
    v_cmp_lt_i32 s[98:99], 27, v212
    v_and_b32_sdwa v128, v219, v88 dst_sel:DWORD dst_unused:UNUSED_PAD src0_sel:DWORD src1_sel:BYTE_3
    v_and_b32_sdwa v129, v219, v89 dst_sel:DWORD dst_unused:UNUSED_PAD src0_sel:DWORD src1_sel:BYTE_3
    v_and_b32_sdwa v130, v219, v90 dst_sel:DWORD dst_unused:UNUSED_PAD src0_sel:DWORD src1_sel:BYTE_3
    v_and_b32_sdwa v131, v219, v91 dst_sel:DWORD dst_unused:UNUSED_PAD src0_sel:DWORD src1_sel:BYTE_3
    s_mov_b64 exec, s[92:93]
    ds_add_rtn_u32 v108, v128, v214
    s_mov_b64 exec, s[94:95]
    ds_add_rtn_u32 v109, v129, v214
    s_mov_b64 exec, s[96:97]
    ds_add_rtn_u32 v110, v130, v214
    s_mov_b64 exec, s[98:99]
    ds_add_rtn_u32 v111, v131, v214
    s_mov_b64 exec, -1
    v_bfe_u32 v232, v88, 14, 12
    v_lshl_add_u32 v232, v232, 5, v213
    v_alignbit_b32 v88, v88, v88, 25
    v_bfe_u32 v233, v89, 14, 12
    v_lshl_add_u32 v233, v233, 5, v213
    v_alignbit_b32 v89, v89, v89, 25
    v_bfe_u32 v234, v90, 14, 12
    v_lshl_add_u32 v234, v234, 5, v213
    v_alignbit_b32 v90, v90, v90, 25
    v_bfe_u32 v235, v91, 14, 12
    v_lshl_add_u32 v235, v235, 5, v213
    v_alignbit_b32 v91, v91, v91, 25
    s_cmp_ge_u32 s51, 2
    s_cbranch_scc1 M_RA
M_RAR:
    s_waitcnt lgkmcnt(0)
    s_barrier
    v_lshlrev_b32 v209, 2, v2
    ds_read_b32 v210, v209
    v_mov_b32 v211, 256
    ds_read_b32 v192, v211
    s_waitcnt lgkmcnt(0)
    v_add_u32 v194, s28, v210
    v_add_u32 v210, 7, v210
    v_and_b32 v210, -8, v210
    v_readfirstlane_b32 s39, v192
    v_mov_b32 v211, v210
    s_nop 1
    v_add_u32_dpp v211, v211, v211 row_shr:1 row_mask:0xf bank_mask:0xf bound_ctrl:1
    s_nop 1
    v_add_u32_dpp v211, v211, v211 row_shr:2 row_mask:0xf bank_mask:0xf bound_ctrl:1
    s_nop 1
    v_add_u32_dpp v211, v211, v211 row_shr:4 row_mask:0xf bank_mask:0xf bound_ctrl:1
    s_nop 1
    v_add_u32_dpp v211, v211, v211 row_shr:8 row_mask:0xf bank_mask:0xf bound_ctrl:1
    s_nop 1
    v_add_u32_dpp v211, v211, v211 row_bcast:15 row_mask:0xa bank_mask:0xf
    s_nop 1
    v_add_u32_dpp v211, v211, v211 row_bcast:31 row_mask:0xc bank_mask:0xf
    v_sub_u32 v210, v211, v210
    v_readlane_b32 s38, v211, 63
    v_add_u32 v195, 20736, v210
    ds_write_b32 v209, v195 offset:512
    s_cmp_gt_u32 s38, 4096
    s_cbranch_scc1 M_SLOW
    s_cmp_lg_u32 s39, 0
    s_cbranch_scc1 M_SLOW
    s_cmp_eq_u32 s51, 0
    s_cbranch_scc1 M_BATCH
    s_cmp_ge_u32 s51, 2
    s_cbranch_scc1 M_RB
M_RBR:
    s_mov_b64 exec, s[92:93]
    ds_read_b32 v128, v128 offset:512
    s_mov_b64 exec, s[94:95]
    ds_read_b32 v129, v129 offset:512
    s_mov_b64 exec, s[96:97]
    ds_read_b32 v130, v130 offset:512
    s_mov_b64 exec, s[98:99]
    ds_read_b32 v131, v131 offset:512
    s_mov_b64 exec, -1
M_BATCH:
    s_mov_b64 exec, s[68:69]
    ds_read_b32 v116, v116 offset:512
    s_mov_b64 exec, s[70:71]
    ds_read_b32 v117, v117 offset:512
    s_mov_b64 exec, s[72:73]
    ds_read_b32 v118, v118 offset:512
    s_mov_b64 exec, s[74:75]
    ds_read_b32 v119, v119 offset:512
    s_mov_b64 exec, s[76:77]
    ds_read_b32 v120, v120 offset:512
    s_mov_b64 exec, s[78:79]
    ds_read_b32 v121, v121 offset:512
    s_mov_b64 exec, s[80:81]
    ds_read_b32 v122, v122 offset:512
    s_mov_b64 exec, s[82:83]
    ds_read_b32 v123, v123 offset:512
    s_mov_b64 exec, s[84:85]
    ds_read_b32 v124, v124 offset:512
    s_mov_b64 exec, s[86:87]
    ds_read_b32 v125, v125 offset:512
    s_mov_b64 exec, s[88:89]
    ds_read_b32 v126, v126 offset:512
    s_mov_b64 exec, s[90:91]
    ds_read_b32 v127, v127 offset:512
    s_mov_b64 exec, -1
    v_add_u32 v196, v210, v194
    v_add_u32 v209, s38, v2
    s_add_u32 s52, s38, 31
    s_and_b32 s52, s52, -32
    s_cmp_eq_u32 s28, 7
    s_cselect_b64 vcc, -1, 0
    v_mov_b32 v194, s52
    v_cndmask_b32 v196, v196, v209, vcc
    v_cndmask_b32 v211, v211, v194, vcc
    v_mov_b32 v209, 2097024
    v_cmp_lt_u32 vcc, v196, v211
    v_mov_b32 v210, 2147483392
    v_lshlrev_b32 v196, 2, v196
    v_add_u32 v196, 82944, v196
    s_mov_b64 exec, vcc
    ds_write2st64_b32 v196, v209, v210 offset1:64
    s_mov_b64 exec, -1
    v_lshrrev_b32 v201, 4, v2
    v_xor_b32 v201, v201, v2
    v_and_b32 v199, 7, v201
    v_lshlrev_b32 v199, 4, v199
    v_xor_b32 v200, 64, v199
    v_and_b32 v201, 1, v201
    v_lshlrev_b32 v201, 4, v201
    s_waitcnt lgkmcnt(0)
    v_add_lshl_u32 v96, v96, v116, 2
    v_add_lshl_u32 v97, v97, v117, 2
    v_add_lshl_u32 v98, v98, v118, 2
    v_add_lshl_u32 v99, v99, v119, 2
    v_add_lshl_u32 v100, v100, v120, 2
    v_add_lshl_u32 v101, v101, v121, 2
    v_add_lshl_u32 v102, v102, v122, 2
    v_add_lshl_u32 v103, v103, v123, 2
    v_add_lshl_u32 v104, v104, v124, 2
    v_add_lshl_u32 v105, v105, v125, 2
    v_add_lshl_u32 v106, v106, v126, 2
    v_add_lshl_u32 v107, v107, v127, 2
    s_mov_b64 exec, s[68:69]
    ds_write2st64_b32 v96, v76, v220 offset1:64
    s_mov_b64 exec, s[70:71]
    ds_write2st64_b32 v97, v77, v221 offset1:64
    s_mov_b64 exec, s[72:73]
    ds_write2st64_b32 v98, v78, v222 offset1:64
    s_mov_b64 exec, s[74:75]
    ds_write2st64_b32 v99, v79, v223 offset1:64
    s_mov_b64 exec, s[76:77]
    ds_write2st64_b32 v100, v80, v224 offset1:64
    s_mov_b64 exec, s[78:79]
    ds_write2st64_b32 v101, v81, v225 offset1:64
    s_mov_b64 exec, s[80:81]
    ds_write2st64_b32 v102, v82, v226 offset1:64
    s_mov_b64 exec, s[82:83]
    ds_write2st64_b32 v103, v83, v227 offset1:64
    s_mov_b64 exec, s[84:85]
    ds_write2st64_b32 v104, v84, v228 offset1:64
    s_mov_b64 exec, s[86:87]
    ds_write2st64_b32 v105, v85, v229 offset1:64
    s_mov_b64 exec, s[88:89]
    ds_write2st64_b32 v106, v86, v230 offset1:64
    s_mov_b64 exec, s[90:91]
    ds_write2st64_b32 v107, v87, v231 offset1:64
    s_mov_b64 exec, -1
    s_cmp_eq_u32 s51, 0
    s_cbranch_scc1 M_NOB3
    v_add_lshl_u32 v108, v108, v128, 2
    v_add_lshl_u32 v109, v109, v129, 2
    v_add_lshl_u32 v110, v110, v130, 2
    v_add_lshl_u32 v111, v111, v131, 2
    s_mov_b64 exec, s[92:93]
    ds_write2st64_b32 v108, v88, v232 offset1:64
    s_mov_b64 exec, s[94:95]
    ds_write2st64_b32 v109, v89, v233 offset1:64
    s_mov_b64 exec, s[96:97]
    ds_write2st64_b32 v110, v90, v234 offset1:64
    s_mov_b64 exec, s[98:99]
    ds_write2st64_b32 v111, v91, v235 offset1:64
    s_mov_b64 exec, -1
M_NOB3:
    s_add_u32 s38, s38, 31
    s_lshr_b32 s52, s38, 7
    s_bfe_u32 s53, s38, 0x20005
    s_lshr_b32 s59, s38, 5
    s_min_u32 s59, s59, 109
    s_sub_u32 s59, 109, s59
    s_mul_i32 s59, s59, 2
    s_lshr_b32 s59, s59, 2
    s_min_u32 s59, s59, 8
    s_add_u32 s43, s59, 1
    s_add_u32 s59, s59, 3
    s_max_u32 s54, s52, s59
    s_sub_u32 s54, s54, s59
    s_lshr_b32 s54, s54, 1
    s_add_u32 s55, s52, 1
    s_max_u32 s56, s55, s59
    s_sub_u32 s56, s56, s59
    s_lshr_b32 s56, s56, 1
    s_sub_u32 s52, s52, s54
    s_sub_u32 s55, s55, s56
    s_mul_i32 s57, s55, s53
    s_sub_u32 s58, 4, s53
    s_mul_i32 s58, s58, s52
    s_add_u32 s57, s57, s58
    s_cmp_ge_u32 s28, 4
    s_cselect_b32 s52, s54, s52
    s_cselect_b32 s55, s56, s55
    s_cselect_b32 s57, s57, 0
    s_cselect_b32 s43, 0, s43
    s_and_b32 s58, s28, 3
    s_cmp_lt_u32 s58, s53
    s_cselect_b32 s30, s55, s52
    s_min_u32 s53, s53, s58
    s_sub_u32 s58, s58, s53
    s_mul_i32 s53, s53, s55
    s_mul_i32 s58, s58, s52
    s_add_u32 s42, s57, s53
    s_add_u32 s42, s42, s58
    s_lshl_b32 s42, s42, 7
    s_add_u32 s42, s42, 82944
    s_lshl_b32 s39, s30, 5
    v_lshrrev_b32 v209, 4, v2
    v_mul_u32_u24 v209, s39, v209
    v_bfe_u32 v210, v2, 3, 1
    v_lshl_add_u32 v209, v210, 4, v209
    v_add_u32 v197, s42, v209
    v_bfe_u32 v209, v2, 3, 2
    v_mul_u32_u24 v209, s39, v209
    v_bfe_u32 v210, v2, 2, 1
    v_lshl_add_u32 v209, v210, 4, v209
    v_lshrrev_b32 v210, 5, v2
    v_lshl_add_u32 v209, v210, 3, v209
    v_bfe_u32 v210, v2, 1, 1
    v_lshl_add_u32 v209, v210, 2, v209
    v_add_u32 v198, s42, v209
    s_sub_u32 s38, s30, 1
    v_min_u32 v209, s38, v2
    v_lshlrev_b32 v209, 5, v209
    v_add_u32 v209, s42, v209
    v_add_u32 v210, s39, v209
    v_add_u32 v211, s39, v210
    v_add_u32 v207, s39, v211
    s_waitcnt vmcnt(1) lgkmcnt(0)
    s_barrier
    ds_read_b128 v[108:111], v197
    ds_read_b32 v112, v198 offset:16384
    ds_read_b32 v209, v209
    ds_read_b32 v210, v210
    ds_read_b32 v211, v211
    ds_read_b32 v207, v207
    ds_read_b128 v[124:127], v197 offset:32
    ds_read_b32 v128, v198 offset:16416
    ds_read_b128 v[192:195], v197 offset:64
    ds_read_b32 v196, v198 offset:16448
    v_lshlrev_b32 v219, 4, v2
    v_add_u32 v219, 33792, v219
    s_cmp_ge_u32 s28, 4
    s_cbranch_scc1 M_NOT0
    s_setprio 1
    s_cmp_eq_u32 s30, 0
    s_waitcnt lgkmcnt(8)
    s_cbranch_scc1 M_NOT0
    s_add_u32 m0, s35, 0
    v_and_or_b32 v108, v108, s37, v199
    buffer_load_dwordx4 v108, s[8:11], 0 offen lds
    s_add_u32 m0, s35, 1024
    v_and_or_b32 v109, v109, s37, v200
    buffer_load_dwordx4 v109, s[8:11], 0 offen lds
    s_add_u32 m0, s35, 2048
    v_and_or_b32 v110, v110, s37, v199
    buffer_load_dwordx4 v110, s[8:11], 0 offen lds
    s_add_u32 m0, s35, 3072
    v_and_or_b32 v111, v111, s37, v200
    buffer_load_dwordx4 v111, s[8:11], 0 offen lds
    s_add_u32 m0, s36, 0
    v_add_u32 v112, v112, v201
    buffer_load_dwordx4 v112, s[12:15], 0 offen lds
M_NOT0:
    s_waitcnt lgkmcnt(0)
    v_bfe_u32 v209, v209, 1, 6
    v_bfe_u32 v210, v210, 1, 6
    v_bfe_u32 v211, v211, 1, 6
    v_bfe_u32 v207, v207, 1, 6
    v_lshl_or_b32 v209, v210, 8, v209
    v_lshl_or_b32 v209, v211, 16, v209
    v_lshl_or_b32 v207, v207, 24, v209
    v_add_u32 v197, 96, v197
    v_mov_b32 v209, v207
    v_readfirstlane_b32 s62, v207
    v_readlane_b32 s63, v207, 32
    v_add_u32 v198, 16480, v198
    v_mov_b32_dpp v209, v207 wave_shr:1 row_mask:0xf bank_mask:0xf
    s_mov_b32 s29, 1
    s_mov_b32 s31, 33
    v_xor_b32 v209, v209, v207
    v_add_u32 v209, 0x3f3f3f3f, v209
    v_and_b32 v209, 0x40404040, v209
    v_or_b32 v207, v207, v209
    s_mov_b64 s[60:61], s[62:63]
    s_bfe_u32 s38, s62, 393216
    s_lshl_b32 s38, s38, 8
    v_add_u32 v209, s38, v208
    ds_read_b32 v76, v209
    ds_read_b32 v92, v209 offset:128
    s_bfe_u32 s38, s62, 393224
    s_lshl_b32 s38, s38, 8
    v_add_u32 v209, s38, v208
    ds_read_b32 v80, v209
    ds_read_b32 v96, v209 offset:128
    s_bfe_u32 s38, s62, 393232
    s_lshl_b32 s38, s38, 8
    v_add_u32 v209, s38, v208
    ds_read_b32 v84, v209
    ds_read_b32 v100, v209 offset:128
    s_bfe_u32 s38, s62, 393240
    s_lshl_b32 s38, s38, 8
    v_add_u32 v209, s38, v208
    ds_read_b32 v88, v209
    ds_read_b32 v104, v209 offset:128
    s_cmp_eq_u32 s40, 2
    s_cbranch_scc1 M_NOWT
    ds_read_b128 v[68:71], v219 offset:41984
    ds_read_b128 v[4:7], v219 offset:4096
    ds_read_b128 v[8:11], v219 offset:5120
    ds_read_b128 v[12:15], v219 offset:6144
    ds_read_b128 v[16:19], v219 offset:7168
    ds_read_b128 v[36:39], v219 offset:20480
    ds_read_b128 v[40:43], v219 offset:21504
    ds_read_b128 v[44:47], v219 offset:22528
    ds_read_b128 v[48:51], v219 offset:23552
    ds_read_b128 v[72:75], v219 offset:44032
    ds_read_b128 v[20:23], v219 offset:12288
    ds_read_b128 v[24:27], v219 offset:13312
    ds_read_b128 v[28:31], v219 offset:14336
    ds_read_b128 v[32:35], v219 offset:15360
    ds_read_b128 v[52:55], v219 offset:28672
    ds_read_b128 v[56:59], v219 offset:29696
    ds_read_b128 v[60:63], v219 offset:30720
    ds_read_b128 v[64:67], v219 offset:31744
    s_cmp_lt_u32 s28, 4
    s_cbranch_scc1 M_TDONE
    s_bfe_u32 s51, s28, 0x10001
    v_subrev_u32 v218, 115712, v218
    v_lshlrev_b32 v218, 1, v218
    v_add_u32 v218, 130048, v218
    v_cvt_f64_f32 v[156:157], v136
    ds_add_f64 v218, v[156:157] offset:0
    v_cvt_f64_f32 v[158:159], v137
    ds_add_f64 v218, v[158:159] offset:512
    v_cvt_f64_f32 v[160:161], v138
    ds_add_f64 v218, v[160:161] offset:1024
    v_cvt_f64_f32 v[162:163], v139
    ds_add_f64 v218, v[162:163] offset:1536
    v_cvt_f64_f32 v[164:165], v140
    ds_add_f64 v218, v[164:165] offset:4096
    v_cvt_f64_f32 v[166:167], v141
    ds_add_f64 v218, v[166:167] offset:4608
    v_cvt_f64_f32 v[168:169], v142
    ds_add_f64 v218, v[168:169] offset:5120
    v_cvt_f64_f32 v[170:171], v143
    ds_add_f64 v218, v[170:171] offset:5632
    v_cvt_f64_f32 v[156:157], v144
    ds_add_f64 v218, v[156:157] offset:8192
    v_cvt_f64_f32 v[158:159], v145
    ds_add_f64 v218, v[158:159] offset:8704
    v_cvt_f64_f32 v[160:161], v146
    ds_add_f64 v218, v[160:161] offset:9216
    v_cvt_f64_f32 v[162:163], v147
    ds_add_f64 v218, v[162:163] offset:9728
    s_cmp_lg_u32 s51, 0
    s_cbranch_scc1 M_TDONE
    v_cvt_f64_f32 v[164:165], v148
    ds_add_f64 v218, v[164:165] offset:12288
    v_cvt_f64_f32 v[166:167], v149
    ds_add_f64 v218, v[166:167] offset:12800
    v_cvt_f64_f32 v[168:169], v150
    ds_add_f64 v218, v[168:169] offset:13312
    v_cvt_f64_f32 v[170:171], v151
    ds_add_f64 v218, v[170:171] offset:13824
M_TDONE:
    s_lshl_b32 s40, s40, 1
    v_and_b32 v215, 63, v2
    v_lshlrev_b32 v215, 3, v215
    v_add_u32 v215, 130048, v215
    v_bfe_u32 v220, v2, 3, 2
    v_and_b32 v221, 3, v2
    v_lshrrev_b32 v222, 5, v2
    v_lshrrev_b32 v224, 1, v220
    v_xor_b32 v223, v224, v220
    v_lshrrev_b32 v225, 2, v2
    v_xor_b32 v223, v223, v225
    v_and_b32 v223, 1, v223
    v_xor_b32 v224, v224, v222
    v_lshlrev_b32 v224, 4, v224
    v_lshl_or_b32 v225, v220, 2, v221
    v_lshl_or_b32 v225, v223, 4, v225
    v_lshl_or_b32 v224, v225, 5, v224
    v_add_u32 v206, s36, v224
    v_and_b32 v224, 1, v221
    v_lshl_or_b32 v225, v223, 1, v224
    v_lshlrev_b32 v225, 3, v225
    v_lshl_or_b32 v225, v220, 1, v225
    v_lshrrev_b32 v221, 1, v221
    v_or_b32 v225, v225, v221
    v_lshlrev_b32 v225, 7, v225
    v_add_u32 v225, s35, v225
    v_lshl_or_b32 v224, v224, 2, v220
    v_xor_b32 v224, v224, v222
    v_xor_b32 v223, 0, v224
    v_lshl_add_u32 v202, v223, 4, v225
    v_xor_b32 v223, 2, v224
    v_lshl_add_u32 v203, v223, 4, v225
    v_xor_b32 v223, 4, v224
    v_lshl_add_u32 v204, v223, 4, v225
    v_xor_b32 v223, 6, v224
    v_lshl_add_u32 v205, v223, 4, v225
M_NOWT:
    v_mov_b64 v[176:177], 0
    v_mov_b64 v[178:179], 0
    v_mov_b64 v[180:181], 0
    v_mov_b64 v[182:183], 0
    v_mov_b64 v[184:185], 0
    v_mov_b64 v[186:187], 0
    v_mov_b64 v[188:189], 0
    v_mov_b64 v[190:191], 0
    v_and_or_b32 v124, v124, s37, v199
    v_and_or_b32 v125, v125, s37, v200
    v_and_or_b32 v126, v126, s37, v199
    v_and_or_b32 v127, v127, s37, v200
    v_add_u32 v128, v128, v201
    v_and_or_b32 v192, v192, s37, v199
    v_and_or_b32 v193, v193, s37, v200
    v_and_or_b32 v194, v194, s37, v199
    v_and_or_b32 v195, v195, s37, v200
    v_add_u32 v196, v196, v201
    v_readlane_b32 s68, v207, 1
    v_readlane_b32 s69, v207, 2
    v_readlane_b32 s70, v207, 3
    v_readlane_b32 s71, v207, 4
    v_readlane_b32 s72, v207, 5
    v_readlane_b32 s73, v207, 6
    v_readlane_b32 s74, v207, 7
    v_readlane_b32 s75, v207, 8
    v_readlane_b32 s76, v207, 9
    v_readlane_b32 s77, v207, 10
    s_cmp_lt_u32 s30, 11
    s_cbranch_scc1 M_SCHD
    v_readlane_b32 s78, v207, 11
    v_readlane_b32 s79, v207, 12
    v_readlane_b32 s80, v207, 13
    s_cmp_lt_u32 s30, 14
    s_cbranch_scc1 M_SCHD
    v_readlane_b32 s81, v207, 14
    v_readlane_b32 s82, v207, 15
    v_readlane_b32 s83, v207, 16
    v_readlane_b32 s84, v207, 17
    s_cmp_lt_u32 s30, 18
    s_cbranch_scc1 M_SCHD
    v_readlane_b32 s85, v207, 18
    v_readlane_b32 s86, v207, 19
    v_readlane_b32 s87, v207, 20
    v_readlane_b32 s88, v207, 21
    v_readlane_b32 s89, v207, 22
    v_readlane_b32 s90, v207, 23
M_SCHD:
    s_cmp_ge_u32 s28, 4
    s_cbranch_scc1 M_YNG
    s_cmp_eq_u32 s30, 0
    s_cbranch_scc1 M_BDONE
    s_cmp_lt_u32 s30, 2
    s_cbranch_scc1 M_W0
    s_add_u32 m0, s35, 4096
    s_nop 0
    buffer_load_dwordx4 v124, s[8:11], 0 offen lds
    s_add_u32 m0, s35, 5120
    s_nop 0
    buffer_load_dwordx4 v125, s[8:11], 0 offen lds
    s_add_u32 m0, s35, 6144
    s_nop 0
    buffer_load_dwordx4 v126, s[8:11], 0 offen lds
    s_add_u32 m0, s35, 7168
    s_nop 0
    buffer_load_dwordx4 v127, s[8:11], 0 offen lds
    s_add_u32 m0, s36, 1024
    s_nop 0
    buffer_load_dwordx4 v128, s[12:15], 0 offen lds
    s_waitcnt vmcnt(5) lgkmcnt(0)
M_W1:
    ds_read_b128 v[172:175], v206
    ds_read_b128 v[156:159], v202
    ds_read_b128 v[160:163], v203
    ds_read_b128 v[164:167], v204
    ds_read_b128 v[168:171], v205
    v_mov_b32 v77, v76
    v_mov_b32 v78, v76
    v_mov_b32 v79, v76
    v_mov_b32 v81, v80
    v_mov_b32 v82, v80
    v_mov_b32 v83, v80
    v_mov_b32 v85, v84
    v_mov_b32 v86, v84
    v_mov_b32 v87, v84
    v_mov_b32 v89, v88
    v_mov_b32 v90, v88
    v_mov_b32 v91, v88
    v_mov_b32 v93, v92
    v_mov_b32 v94, v92
    v_mov_b32 v95, v92
    v_mov_b32 v97, v96
    v_mov_b32 v98, v96
    v_mov_b32 v99, v96
    v_mov_b32 v101, v100
    v_mov_b32 v102, v100
    v_mov_b32 v103, v100
    v_mov_b32 v105, v104
    v_mov_b32 v106, v104
    v_mov_b32 v107, v104
    s_waitcnt lgkmcnt(0)
    v_mfma_f32_32x32x16_bf16 v[108:123], v[172:175], v[68:71], v[76:91]
    v_mfma_f32_32x32x16_bf16 v[108:123], v[156:159], v[4:7], v[108:123]
    v_mfma_f32_32x32x16_bf16 v[108:123], v[160:163], v[8:11], v[108:123]
    v_mfma_f32_32x32x16_bf16 v[108:123], v[164:167], v[12:15], v[108:123]
    v_mfma_f32_32x32x16_bf16 v[108:123], v[168:171], v[16:19], v[108:123]
    s_cmp_eq_u32 s43, 0
    s_cbranch_scc1 M_YNG2
    s_nop 3
M_GO:
    .p2align 6
M_LOOP0:
    s_bitcmp1_b32 s62, 6
    s_cbranch_scc1 M_F00
M_FR00:
    s_bitcmp1_b32 s62, 14
    s_cbranch_scc1 M_F01
M_FR01:
    s_bitcmp1_b32 s62, 22
    s_cbranch_scc1 M_F02
M_FR02:
    s_bitcmp1_b32 s62, 30
    s_cbranch_scc1 M_F03
M_FR03:
    s_cmp_eq_u32 s29, s43
    s_cbranch_scc1 M_SB0
M_SBR0:
    s_setprio 0
    s_add_u32 s38, s29, 1
    s_cmp_lt_u32 s38, s30
    s_cbranch_scc0 M_ND0
    s_add_u32 m0, s35, 0
    s_nop 0
    buffer_load_dwordx4 v192, s[8:11], 0 offen lds
    s_add_u32 m0, s35, 1024
    s_nop 0
    buffer_load_dwordx4 v193, s[8:11], 0 offen lds
    s_add_u32 m0, s35, 2048
    s_nop 0
    buffer_load_dwordx4 v194, s[8:11], 0 offen lds
    s_add_u32 m0, s35, 3072
    s_nop 0
    buffer_load_dwordx4 v195, s[8:11], 0 offen lds
    s_add_u32 m0, s36, 0
    s_nop 0
    buffer_load_dwordx4 v196, s[12:15], 0 offen lds
M_ND0:
    s_mov_b32 m0, s29
    s_nop 0
    s_movrels_b32 s64, s67
    .p2align 3
    v_exp_f32 v108, v108
    s_setprio 1
    v_exp_f32 v109, v109
    v_exp_f32 v110, v110
    v_mfma_f32_32x32x16_bf16 v[140:155], v[156:159], v[36:39], 0
    v_exp_f32 v111, v111
    v_exp_f32 v112, v112
    v_exp_f32 v113, v113
    v_mfma_f32_32x32x16_bf16 v[140:155], v[160:163], v[40:43], v[140:155]
    v_exp_f32 v114, v114
    v_exp_f32 v115, v115
    s_setprio 2
    v_exp_f32 v116, v116
    v_mfma_f32_32x32x16_bf16 v[140:155], v[164:167], v[44:47], v[140:155]
    v_exp_f32 v117, v117
    v_exp_f32 v118, v118
    v_exp_f32 v119, v119
    v_mfma_f32_32x32x16_bf16 v[140:155], v[168:171], v[48:51], v[140:155]
    v_exp_f32 v120, v120
    v_exp_f32 v121, v121
    v_exp_f32 v122, v122
    v_exp_f32 v123, v123
    v_pk_add_f32 v[108:109], v[108:109], s[44:45]
    v_pk_add_f32 v[110:111], v[110:111], s[44:45]
    v_pk_add_f32 v[112:113], v[112:113], s[44:45]
    v_pk_add_f32 v[114:115], v[114:115], s[44:45]
    v_pk_add_f32 v[116:117], v[116:117], s[44:45]
    v_pk_add_f32 v[118:119], v[118:119], s[44:45]
    v_pk_add_f32 v[120:121], v[120:121], s[44:45]
    v_pk_add_f32 v[122:123], v[122:123], s[44:45]
    v_mfma_f32_32x32x16_bf16 v[124:139], v[172:175], v[72:75], v[92:107]
    v_rcp_f32 v108, v108
    v_rcp_f32 v109, v109
    v_rcp_f32 v110, v110
    v_mfma_f32_32x32x16_bf16 v[124:139], v[156:159], v[20:23], v[124:139]
    v_rcp_f32 v111, v111
    v_rcp_f32 v112, v112
    v_rcp_f32 v113, v113
    v_mfma_f32_32x32x16_bf16 v[124:139], v[160:163], v[24:27], v[124:139]
    v_rcp_f32 v114, v114
    v_rcp_f32 v115, v115
    v_rcp_f32 v116, v116
    v_mfma_f32_32x32x16_bf16 v[124:139], v[164:167], v[28:31], v[124:139]
    v_rcp_f32 v117, v117
    v_rcp_f32 v118, v118
    v_rcp_f32 v119, v119
    v_mfma_f32_32x32x16_bf16 v[124:139], v[168:171], v[32:35], v[124:139]
    v_rcp_f32 v120, v120
    v_rcp_f32 v121, v121
    v_rcp_f32 v122, v122
    v_rcp_f32 v123, v123
    v_pk_fma_f32 v[176:177], v[108:109], v[140:141], v[176:177]
    v_pk_fma_f32 v[178:179], v[112:113], v[144:145], v[178:179]
    v_pk_fma_f32 v[180:181], v[116:117], v[148:149], v[180:181]
    v_pk_fma_f32 v[182:183], v[120:121], v[152:153], v[182:183]
    v_pk_fma_f32 v[176:177], v[110:111], v[142:143], v[176:177]
    v_pk_fma_f32 v[178:179], v[114:115], v[146:147], v[178:179]
    v_pk_fma_f32 v[180:181], v[118:119], v[150:151], v[180:181]
    v_pk_fma_f32 v[182:183], v[122:123], v[154:155], v[182:183]
    s_add_u32 s38, s29, 1
    s_cmp_lt_u32 s38, s30
    s_cbranch_scc0 M_WZ0
    s_waitcnt vmcnt(5)
M_WZR0:
    ds_read_b128 v[172:175], v206 offset:1024
    ds_read_b128 v[220:223], v202 offset:4096
    ds_read_b128 v[224:227], v203 offset:4096
    ds_read_b128 v[228:231], v204 offset:4096
    ds_read_b128 v[232:235], v205 offset:4096
    ds_read_b128 v[192:195], v197 offset:0
    ds_read_b32 v196, v198 offset:0
    s_bitcmp1_b32 s64, 6
    s_cbranch_scc1 M_X00
M_XR00:
    s_bitcmp1_b32 s64, 14
    s_cbranch_scc1 M_X01
M_XR01:
    s_bitcmp1_b32 s64, 22
    s_cbranch_scc1 M_X02
M_XR02:
    s_bitcmp1_b32 s64, 30
    s_cbranch_scc1 M_X03
M_XR03:
    s_setprio 0
    s_waitcnt lgkmcnt(0)
    .p2align 3
    v_exp_f32 v124, v124
    s_setprio 1
    v_exp_f32 v125, v125
    v_exp_f32 v126, v126
    v_mfma_f32_32x32x16_bf16 v[140:155], v[156:159], v[52:55], 0
    v_exp_f32 v127, v127
    v_exp_f32 v128, v128
    v_exp_f32 v129, v129
    v_mfma_f32_32x32x16_bf16 v[140:155], v[160:163], v[56:59], v[140:155]
    v_exp_f32 v130, v130
    v_exp_f32 v131, v131
    s_setprio 2
    v_exp_f32 v132, v132
    v_mfma_f32_32x32x16_bf16 v[140:155], v[164:167], v[60:63], v[140:155]
    v_exp_f32 v133, v133
    v_exp_f32 v134, v134
    v_exp_f32 v135, v135
    v_mfma_f32_32x32x16_bf16 v[140:155], v[168:171], v[64:67], v[140:155]
    v_exp_f32 v136, v136
    v_exp_f32 v137, v137
    v_exp_f32 v138, v138
    v_exp_f32 v139, v139
    v_pk_add_f32 v[124:125], v[124:125], s[44:45]
    v_pk_add_f32 v[126:127], v[126:127], s[44:45]
    v_pk_add_f32 v[128:129], v[128:129], s[44:45]
    v_pk_add_f32 v[130:131], v[130:131], s[44:45]
    v_pk_add_f32 v[132:133], v[132:133], s[44:45]
    v_pk_add_f32 v[134:135], v[134:135], s[44:45]
    v_pk_add_f32 v[136:137], v[136:137], s[44:45]
    v_pk_add_f32 v[138:139], v[138:139], s[44:45]
    v_mfma_f32_32x32x16_bf16 v[108:123], v[172:175], v[68:71], v[76:91]
    v_rcp_f32 v124, v124
    v_rcp_f32 v125, v125
    v_rcp_f32 v126, v126
    v_mfma_f32_32x32x16_bf16 v[108:123], v[220:223], v[4:7], v[108:123]
    v_rcp_f32 v127, v127
    v_rcp_f32 v128, v128
    v_rcp_f32 v129, v129
    v_mfma_f32_32x32x16_bf16 v[108:123], v[224:227], v[8:11], v[108:123]
    v_rcp_f32 v130, v130
    v_rcp_f32 v131, v131
    v_rcp_f32 v132, v132
    v_mfma_f32_32x32x16_bf16 v[108:123], v[228:231], v[12:15], v[108:123]
    v_rcp_f32 v133, v133
    v_rcp_f32 v134, v134
    v_rcp_f32 v135, v135
    v_mfma_f32_32x32x16_bf16 v[108:123], v[232:235], v[16:19], v[108:123]
    v_rcp_f32 v136, v136
    v_rcp_f32 v137, v137
    v_rcp_f32 v138, v138
    v_rcp_f32 v139, v139
    v_pk_fma_f32 v[184:185], v[124:125], v[140:141], v[184:185]
    v_pk_fma_f32 v[186:187], v[128:129], v[144:145], v[186:187]
    v_pk_fma_f32 v[188:189], v[132:133], v[148:149], v[188:189]
    v_pk_fma_f32 v[190:191], v[136:137], v[152:153], v[190:191]
    v_pk_fma_f32 v[184:185], v[126:127], v[142:143], v[184:185]
    v_pk_fma_f32 v[186:187], v[130:131], v[146:147], v[186:187]
    v_pk_fma_f32 v[188:189], v[134:135], v[150:151], v[188:189]
    v_pk_fma_f32 v[190:191], v[138:139], v[154:155], v[190:191]
    v_and_or_b32 v192, v192, s37, v199
    v_and_or_b32 v193, v193, s37, v200
    v_and_or_b32 v194, v194, s37, v199
    v_and_or_b32 v195, v195, s37, v200
    v_add_u32 v196, v196, v201
    s_mov_b64 s[60:61], s[62:63]
    s_mov_b64 s[62:63], s[64:65]
    s_add_u32 s29, s29, 1
    s_cmp_le_u32 s29, s30
    s_cbranch_scc0 M_LEND
M_LOOP1:
    s_bitcmp1_b32 s62, 6
    s_cbranch_scc1 M_F10
M_FR10:
    s_bitcmp1_b32 s62, 14
    s_cbranch_scc1 M_F11
M_FR11:
    s_bitcmp1_b32 s62, 22
    s_cbranch_scc1 M_F12
M_FR12:
    s_bitcmp1_b32 s62, 30
    s_cbranch_scc1 M_F13
M_FR13:
    s_cmp_eq_u32 s29, s43
    s_cbranch_scc1 M_SB1
M_SBR1:
    s_setprio 0
    s_add_u32 s38, s29, 1
    s_cmp_lt_u32 s38, s30
    s_cbranch_scc0 M_ND1
    s_add_u32 m0, s35, 4096
    s_nop 0
    buffer_load_dwordx4 v192, s[8:11], 0 offen lds
    s_add_u32 m0, s35, 5120
    s_nop 0
    buffer_load_dwordx4 v193, s[8:11], 0 offen lds
    s_add_u32 m0, s35, 6144
    s_nop 0
    buffer_load_dwordx4 v194, s[8:11], 0 offen lds
    s_add_u32 m0, s35, 7168
    s_nop 0
    buffer_load_dwordx4 v195, s[8:11], 0 offen lds
    s_add_u32 m0, s36, 1024
    s_nop 0
    buffer_load_dwordx4 v196, s[12:15], 0 offen lds
M_ND1:
    s_mov_b32 m0, s29
    s_nop 0
    s_movrels_b32 s64, s67
    .p2align 3
    v_exp_f32 v108, v108
    s_setprio 1
    v_exp_f32 v109, v109
    v_exp_f32 v110, v110
    v_mfma_f32_32x32x16_bf16 v[140:155], v[220:223], v[36:39], 0
    v_exp_f32 v111, v111
    v_exp_f32 v112, v112
    v_exp_f32 v113, v113
    v_mfma_f32_32x32x16_bf16 v[140:155], v[224:227], v[40:43], v[140:155]
    v_exp_f32 v114, v114
    v_exp_f32 v115, v115
    s_setprio 2
    v_exp_f32 v116, v116
    v_mfma_f32_32x32x16_bf16 v[140:155], v[228:231], v[44:47], v[140:155]
    v_exp_f32 v117, v117
    v_exp_f32 v118, v118
    v_exp_f32 v119, v119
    v_mfma_f32_32x32x16_bf16 v[140:155], v[232:235], v[48:51], v[140:155]
    v_exp_f32 v120, v120
    v_exp_f32 v121, v121
    v_exp_f32 v122, v122
    v_exp_f32 v123, v123
    v_pk_add_f32 v[108:109], v[108:109], s[44:45]
    v_pk_add_f32 v[110:111], v[110:111], s[44:45]
    v_pk_add_f32 v[112:113], v[112:113], s[44:45]
    v_pk_add_f32 v[114:115], v[114:115], s[44:45]
    v_pk_add_f32 v[116:117], v[116:117], s[44:45]
    v_pk_add_f32 v[118:119], v[118:119], s[44:45]
    v_pk_add_f32 v[120:121], v[120:121], s[44:45]
    v_pk_add_f32 v[122:123], v[122:123], s[44:45]
    v_mfma_f32_32x32x16_bf16 v[124:139], v[172:175], v[72:75], v[92:107]
    v_rcp_f32 v108, v108
    v_rcp_f32 v109, v109
    v_rcp_f32 v110, v110
    v_mfma_f32_32x32x16_bf16 v[124:139], v[220:223], v[20:23], v[124:139]
    v_rcp_f32 v111, v111
    v_rcp_f32 v112, v112
    v_rcp_f32 v113, v113
    v_mfma_f32_32x32x16_bf16 v[124:139], v[224:227], v[24:27], v[124:139]
    v_rcp_f32 v114, v114
    v_rcp_f32 v115, v115
    v_rcp_f32 v116, v116
    v_mfma_f32_32x32x16_bf16 v[124:139], v[228:231], v[28:31], v[124:139]
    v_rcp_f32 v117, v117
    v_rcp_f32 v118, v118
    v_rcp_f32 v119, v119
    v_mfma_f32_32x32x16_bf16 v[124:139], v[232:235], v[32:35], v[124:139]
    v_rcp_f32 v120, v120
    v_rcp_f32 v121, v121
    v_rcp_f32 v122, v122
    v_rcp_f32 v123, v123
    v_pk_fma_f32 v[176:177], v[108:109], v[140:141], v[176:177]
    v_pk_fma_f32 v[178:179], v[112:113], v[144:145], v[178:179]
    v_pk_fma_f32 v[180:181], v[116:117], v[148:149], v[180:181]
    v_pk_fma_f32 v[182:183], v[120:121], v[152:153], v[182:183]
    v_pk_fma_f32 v[176:177], v[110:111], v[142:143], v[176:177]
    v_pk_fma_f32 v[178:179], v[114:115], v[146:147], v[178:179]
    v_pk_fma_f32 v[180:181], v[118:119], v[150:151], v[180:181]
    v_pk_fma_f32 v[182:183], v[122:123], v[154:155], v[182:183]
    s_add_u32 s38, s29, 1
    s_cmp_lt_u32 s38, s30
    s_cbranch_scc0 M_WZ1
    s_waitcnt vmcnt(5)
M_WZR1:
    ds_read_b128 v[172:175], v206 offset:0
    ds_read_b128 v[156:159], v202 offset:0
    ds_read_b128 v[160:163], v203 offset:0
    ds_read_b128 v[164:167], v204 offset:0
    ds_read_b128 v[168:171], v205 offset:0
    ds_read_b128 v[192:195], v197 offset:32
    ds_read_b32 v196, v198 offset:32
    s_bitcmp1_b32 s64, 6
    s_cbranch_scc1 M_X10
M_XR10:
    s_bitcmp1_b32 s64, 14
    s_cbranch_scc1 M_X11
M_XR11:
    s_bitcmp1_b32 s64, 22
    s_cbranch_scc1 M_X12
M_XR12:
    s_bitcmp1_b32 s64, 30
    s_cbranch_scc1 M_X13
M_XR13:
    s_setprio 0
    s_waitcnt lgkmcnt(0)
    .p2align 3
    v_exp_f32 v124, v124
    s_setprio 1
    v_exp_f32 v125, v125
    v_exp_f32 v126, v126
    v_mfma_f32_32x32x16_bf16 v[140:155], v[220:223], v[52:55], 0
    v_exp_f32 v127, v127
    v_exp_f32 v128, v128
    v_exp_f32 v129, v129
    v_mfma_f32_32x32x16_bf16 v[140:155], v[224:227], v[56:59], v[140:155]
    v_exp_f32 v130, v130
    v_exp_f32 v131, v131
    s_setprio 2
    v_exp_f32 v132, v132
    v_mfma_f32_32x32x16_bf16 v[140:155], v[228:231], v[60:63], v[140:155]
    v_exp_f32 v133, v133
    v_exp_f32 v134, v134
    v_exp_f32 v135, v135
    v_mfma_f32_32x32x16_bf16 v[140:155], v[232:235], v[64:67], v[140:155]
    v_exp_f32 v136, v136
    v_exp_f32 v137, v137
    v_exp_f32 v138, v138
    v_exp_f32 v139, v139
    v_pk_add_f32 v[124:125], v[124:125], s[44:45]
    v_pk_add_f32 v[126:127], v[126:127], s[44:45]
    v_pk_add_f32 v[128:129], v[128:129], s[44:45]
    v_pk_add_f32 v[130:131], v[130:131], s[44:45]
    v_pk_add_f32 v[132:133], v[132:133], s[44:45]
    v_pk_add_f32 v[134:135], v[134:135], s[44:45]
    v_pk_add_f32 v[136:137], v[136:137], s[44:45]
    v_pk_add_f32 v[138:139], v[138:139], s[44:45]
    v_mfma_f32_32x32x16_bf16 v[108:123], v[172:175], v[68:71], v[76:91]
    v_rcp_f32 v124, v124
    v_rcp_f32 v125, v125
    v_rcp_f32 v126, v126
    v_mfma_f32_32x32x16_bf16 v[108:123], v[156:159], v[4:7], v[108:123]
    v_rcp_f32 v127, v127
    v_rcp_f32 v128, v128
    v_rcp_f32 v129, v129
    v_mfma_f32_32x32x16_bf16 v[108:123], v[160:163], v[8:11], v[108:123]
    v_rcp_f32 v130, v130
    v_rcp_f32 v131, v131
    v_rcp_f32 v132, v132
    v_mfma_f32_32x32x16_bf16 v[108:123], v[164:167], v[12:15], v[108:123]
    v_rcp_f32 v133, v133
    v_rcp_f32 v134, v134
    v_rcp_f32 v135, v135
    v_mfma_f32_32x32x16_bf16 v[108:123], v[168:171], v[16:19], v[108:123]
    v_rcp_f32 v136, v136
    v_rcp_f32 v137, v137
    v_rcp_f32 v138, v138
    v_rcp_f32 v139, v139
    v_pk_fma_f32 v[184:185], v[124:125], v[140:141], v[184:185]
    v_pk_fma_f32 v[186:187], v[128:129], v[144:145], v[186:187]
    v_pk_fma_f32 v[188:189], v[132:133], v[148:149], v[188:189]
    v_pk_fma_f32 v[190:191], v[136:137], v[152:153], v[190:191]
    v_pk_fma_f32 v[184:185], v[126:127], v[142:143], v[184:185]
    v_pk_fma_f32 v[186:187], v[130:131], v[146:147], v[186:187]
    v_pk_fma_f32 v[188:189], v[134:135], v[150:151], v[188:189]
    v_pk_fma_f32 v[190:191], v[138:139], v[154:155], v[190:191]
    v_and_or_b32 v192, v192, s37, v199
    v_and_or_b32 v193, v193, s37, v200
    v_and_or_b32 v194, v194, s37, v199
    v_and_or_b32 v195, v195, s37, v200
    v_add_u32 v196, v196, v201
    v_add_u32 v197, 64, v197
    v_add_u32 v198, 64, v198
    s_mov_b64 s[60:61], s[62:63]
    s_mov_b64 s[62:63], s[64:65]
    s_add_u32 s29, s29, 1
    s_cmp_le_u32 s29, s30
    s_cbranch_scc1 M_LOOP0
M_LEND:
    v_add_f32 v108, v176, v177
    v_add_f32 v112, v184, v185
    s_bfe_u32 s96, s60, 393216
    s_lshl_b32 s96, s96, 9
    v_add_f32 v109, v178, v179
    v_add_f32 v113, v186, v187
    s_bfe_u32 s97, s60, 393224
    s_lshl_b32 s97, s97, 9
    v_add_f32 v110, v180, v181
    v_add_f32 v114, v188, v189
    s_bfe_u32 s98, s60, 393232
    s_lshl_b32 s98, s98, 9
    v_add_f32 v111, v182, v183
    v_add_f32 v115, v190, v191
    s_bfe_u32 s99, s60, 393240
    s_lshl_b32 s99, s99, 9
    v_permlane32_swap_b32 v108, v112
    v_add_u32 v116, s96, v215
    v_permlane32_swap_b32 v109, v113
    v_add_u32 v117, s97, v215
    v_permlane32_swap_b32 v110, v114
    v_add_u32 v118, s98, v215
    v_permlane32_swap_b32 v111, v115
    v_add_u32 v119, s99, v215
    v_add_f32 v108, v108, v112
    v_add_f32 v109, v109, v113
    v_add_f32 v110, v110, v114
    v_add_f32 v111, v111, v115
    v_cvt_f64_f32 v[124:125], v108
    ds_add_f64 v116, v[124:125]
    v_cvt_f64_f32 v[126:127], v109
    ds_add_f64 v117, v[126:127]
    v_cvt_f64_f32 v[128:129], v110
    ds_add_f64 v118, v[128:129]
    v_cvt_f64_f32 v[130:131], v111
    ds_add_f64 v119, v[130:131]
M_BDONE:
    s_cmp_lt_u32 s30, s43
    s_cbranch_scc0 M_BDONE2
    s_waitcnt lgkmcnt(0)
    s_barrier
M_BDONE2:
    s_setprio 0
    s_cmp_lg_u32 s40, 0
    s_cbranch_scc1 M_SNEXT
M_EPI:
    v_lshlrev_b32 v209, 4, v0
    v_add_u32 v209, 130048, v209
    s_mov_b32 s38, 3216550459
    s_mul_i32 s39, s50, 6272
    s_add_u32 s34, s39, 4096
    v_lshlrev_b32 v210, 2, v0
    s_cmp_lg_u32 s28, 0
    s_waitcnt lgkmcnt(0)
    s_barrier
    s_cbranch_scc1 M_EP3
    ds_read_b128 v[136:139], v209 offset:24576
M_EP3:
    ds_read_b128 v[124:127], v209
    ds_read_b128 v[128:131], v209 offset:8192
    ds_read_b128 v[132:135], v209 offset:16384
    s_waitcnt lgkmcnt(2)
    v_cvt_f32_f64 v108, v[124:125]
    v_cvt_f32_f64 v109, v[126:127]
    s_waitcnt lgkmcnt(1)
    v_cvt_f32_f64 v110, v[128:129]
    v_cvt_f32_f64 v111, v[130:131]
    s_waitcnt lgkmcnt(0)
    v_cvt_f32_f64 v112, v[132:133]
    v_cvt_f32_f64 v113, v[134:135]
    v_mul_f32 v116, s38, v108
    v_mul_f32 v117, s38, v109
    v_mul_f32 v118, s38, v110
    v_mul_f32 v119, s38, v111
    v_mul_f32 v120, s38, v112
    v_mul_f32 v121, s38, v113
    v_exp_f32 v116, v116
    v_exp_f32 v117, v117
    v_exp_f32 v118, v118
    v_exp_f32 v119, v119
    v_exp_f32 v120, v120
    v_exp_f32 v121, v121
    v_add_f32 v116, 1.0, v116
    v_add_f32 v117, 1.0, v117
    v_add_f32 v118, 1.0, v118
    v_add_f32 v119, 1.0, v119
    v_add_f32 v120, 1.0, v120
    v_add_f32 v121, 1.0, v121
    v_rcp_f32 v116, v116
    v_rcp_f32 v117, v117
    v_rcp_f32 v118, v118
    v_rcp_f32 v119, v119
    v_rcp_f32 v120, v120
    v_rcp_f32 v121, v121
    v_mul_f32 v108, v108, v116
    v_mul_f32 v109, v109, v117
    v_mul_f32 v110, v110, v118
    v_mul_f32 v111, v111, v119
    v_mul_f32 v112, v112, v120
    v_mul_f32 v113, v113, v121
    v_cvt_pk_bf16_f32 v124, v108, v109
    v_cvt_pk_bf16_f32 v125, v110, v111
    v_cvt_pk_bf16_f32 v126, v112, v113
    buffer_store_dword v124, v210, s[20:23], s39 offen sc1
    buffer_store_dword v125, v210, s[20:23], s39 offen offset:2048 sc1
    buffer_store_dword v126, v210, s[20:23], s34 offen sc1
    s_cbranch_scc1 M_FIN
    s_mov_b32 exec_hi, 0
    v_cvt_f32_f64 v114, v[136:137]
    v_cvt_f32_f64 v115, v[138:139]
    v_mul_f32 v122, s38, v114
    v_mul_f32 v123, s38, v115
    v_exp_f32 v122, v122
    v_exp_f32 v123, v123
    v_add_f32 v122, 1.0, v122
    v_add_f32 v123, 1.0, v123
    v_rcp_f32 v122, v122
    v_rcp_f32 v123, v123
    v_mul_f32 v114, v114, v122
    v_mul_f32 v115, v115, v123
    v_cvt_pk_bf16_f32 v127, v114, v115
    buffer_store_dword v127, v210, s[20:23], s34 offen offset:2048 sc1
M_FIN:
M_END:
    s_endpgm
M_F00:
    s_setprio 3
    v_add_f32 v210, v176, v177
    v_add_f32 v211, v184, v185
    s_bfe_u32 s38, s60, 393216
    s_lshl_b32 s38, s38, 9
    v_permlane32_swap_b32 v210, v211
    v_add_u32 v209, s38, v215
    v_mov_b64 v[176:177], 0
    v_add_f32 v210, v210, v211
    v_mov_b64 v[184:185], 0
    v_cvt_f64_f32 v[216:217], v210
    ds_add_f64 v209, v[216:217]
    s_branch M_FR00
M_X00:
    s_setprio 3
    s_bfe_u32 s38, s64, 393216
    s_lshl_b32 s38, s38, 8
    v_add_u32 v209, s38, v208
    ds_read2_b32 v[76:77], v209
    ds_read2_b32 v[78:79], v209
    ds_read2_b32 v[92:93], v209 offset0:32 offset1:32
    ds_read2_b32 v[94:95], v209 offset0:32 offset1:32
    s_branch M_XR00
M_F01:
    s_setprio 3
    v_add_f32 v210, v178, v179
    v_add_f32 v211, v186, v187
    s_bfe_u32 s38, s60, 393224
    s_lshl_b32 s38, s38, 9
    v_permlane32_swap_b32 v210, v211
    v_add_u32 v209, s38, v215
    v_mov_b64 v[178:179], 0
    v_add_f32 v210, v210, v211
    v_mov_b64 v[186:187], 0
    v_cvt_f64_f32 v[216:217], v210
    ds_add_f64 v209, v[216:217]
    s_branch M_FR01
M_X01:
    s_setprio 3
    s_bfe_u32 s38, s64, 393224
    s_lshl_b32 s38, s38, 8
    v_add_u32 v209, s38, v208
    ds_read2_b32 v[80:81], v209
    ds_read2_b32 v[82:83], v209
    ds_read2_b32 v[96:97], v209 offset0:32 offset1:32
    ds_read2_b32 v[98:99], v209 offset0:32 offset1:32
    s_branch M_XR01
M_F02:
    s_setprio 3
    v_add_f32 v210, v180, v181
    v_add_f32 v211, v188, v189
    s_bfe_u32 s38, s60, 393232
    s_lshl_b32 s38, s38, 9
    v_permlane32_swap_b32 v210, v211
    v_add_u32 v209, s38, v215
    v_mov_b64 v[180:181], 0
    v_add_f32 v210, v210, v211
    v_mov_b64 v[188:189], 0
    v_cvt_f64_f32 v[216:217], v210
    ds_add_f64 v209, v[216:217]
    s_branch M_FR02
M_X02:
    s_setprio 3
    s_bfe_u32 s38, s64, 393232
    s_lshl_b32 s38, s38, 8
    v_add_u32 v209, s38, v208
    ds_read2_b32 v[84:85], v209
    ds_read2_b32 v[86:87], v209
    ds_read2_b32 v[100:101], v209 offset0:32 offset1:32
    ds_read2_b32 v[102:103], v209 offset0:32 offset1:32
    s_branch M_XR02
M_F03:
    s_setprio 3
    v_add_f32 v210, v182, v183
    v_add_f32 v211, v190, v191
    s_bfe_u32 s38, s60, 393240
    s_lshl_b32 s38, s38, 9
    v_permlane32_swap_b32 v210, v211
    v_add_u32 v209, s38, v215
    v_mov_b64 v[182:183], 0
    v_add_f32 v210, v210, v211
    v_mov_b64 v[190:191], 0
    v_cvt_f64_f32 v[216:217], v210
    ds_add_f64 v209, v[216:217]
    s_branch M_FR03
M_X03:
    s_setprio 3
    s_bfe_u32 s38, s64, 393240
    s_lshl_b32 s38, s38, 8
    v_add_u32 v209, s38, v208
    ds_read2_b32 v[88:89], v209
    ds_read2_b32 v[90:91], v209
    ds_read2_b32 v[104:105], v209 offset0:32 offset1:32
    ds_read2_b32 v[106:107], v209 offset0:32 offset1:32
    s_branch M_XR03
M_WZ0:
    s_waitcnt vmcnt(0)
    s_branch M_WZR0
M_SB0:
    s_barrier
    s_branch M_SBR0
M_F10:
    s_setprio 3
    v_add_f32 v210, v176, v177
    v_add_f32 v211, v184, v185
    s_bfe_u32 s38, s60, 393216
    s_lshl_b32 s38, s38, 9
    v_permlane32_swap_b32 v210, v211
    v_add_u32 v209, s38, v215
    v_mov_b64 v[176:177], 0
    v_add_f32 v210, v210, v211
    v_mov_b64 v[184:185], 0
    v_cvt_f64_f32 v[216:217], v210
    ds_add_f64 v209, v[216:217]
    s_branch M_FR10
M_X10:
    s_setprio 3
    s_bfe_u32 s38, s64, 393216
    s_lshl_b32 s38, s38, 8
    v_add_u32 v209, s38, v208
    ds_read2_b32 v[76:77], v209
    ds_read2_b32 v[78:79], v209
    ds_read2_b32 v[92:93], v209 offset0:32 offset1:32
    ds_read2_b32 v[94:95], v209 offset0:32 offset1:32
    s_branch M_XR10
M_F11:
    s_setprio 3
    v_add_f32 v210, v178, v179
    v_add_f32 v211, v186, v187
    s_bfe_u32 s38, s60, 393224
    s_lshl_b32 s38, s38, 9
    v_permlane32_swap_b32 v210, v211
    v_add_u32 v209, s38, v215
    v_mov_b64 v[178:179], 0
    v_add_f32 v210, v210, v211
    v_mov_b64 v[186:187], 0
    v_cvt_f64_f32 v[216:217], v210
    ds_add_f64 v209, v[216:217]
    s_branch M_FR11
M_X11:
    s_setprio 3
    s_bfe_u32 s38, s64, 393224
    s_lshl_b32 s38, s38, 8
    v_add_u32 v209, s38, v208
    ds_read2_b32 v[80:81], v209
    ds_read2_b32 v[82:83], v209
    ds_read2_b32 v[96:97], v209 offset0:32 offset1:32
    ds_read2_b32 v[98:99], v209 offset0:32 offset1:32
    s_branch M_XR11
M_F12:
    s_setprio 3
    v_add_f32 v210, v180, v181
    v_add_f32 v211, v188, v189
    s_bfe_u32 s38, s60, 393232
    s_lshl_b32 s38, s38, 9
    v_permlane32_swap_b32 v210, v211
    v_add_u32 v209, s38, v215
    v_mov_b64 v[180:181], 0
    v_add_f32 v210, v210, v211
    v_mov_b64 v[188:189], 0
    v_cvt_f64_f32 v[216:217], v210
    ds_add_f64 v209, v[216:217]
    s_branch M_FR12
M_X12:
    s_setprio 3
    s_bfe_u32 s38, s64, 393232
    s_lshl_b32 s38, s38, 8
    v_add_u32 v209, s38, v208
    ds_read2_b32 v[84:85], v209
    ds_read2_b32 v[86:87], v209
    ds_read2_b32 v[100:101], v209 offset0:32 offset1:32
    ds_read2_b32 v[102:103], v209 offset0:32 offset1:32
    s_branch M_XR12
M_F13:
    s_setprio 3
    v_add_f32 v210, v182, v183
    v_add_f32 v211, v190, v191
    s_bfe_u32 s38, s60, 393240
    s_lshl_b32 s38, s38, 9
    v_permlane32_swap_b32 v210, v211
    v_add_u32 v209, s38, v215
    v_mov_b64 v[182:183], 0
    v_add_f32 v210, v210, v211
    v_mov_b64 v[190:191], 0
    v_cvt_f64_f32 v[216:217], v210
    ds_add_f64 v209, v[216:217]
    s_branch M_FR13
M_X13:
    s_setprio 3
    s_bfe_u32 s38, s64, 393240
    s_lshl_b32 s38, s38, 8
    v_add_u32 v209, s38, v208
    ds_read2_b32 v[88:89], v209
    ds_read2_b32 v[90:91], v209
    ds_read2_b32 v[104:105], v209 offset0:32 offset1:32
    ds_read2_b32 v[106:107], v209 offset0:32 offset1:32
    s_branch M_XR13
M_WZ1:
    s_waitcnt vmcnt(0)
    s_branch M_WZR1
M_SB1:
    s_barrier
    s_branch M_SBR1
M_W0:
    s_waitcnt vmcnt(0) lgkmcnt(0)
    s_branch M_W1
M_YNG:
    s_cmp_eq_u32 s30, 0
    s_cbranch_scc1 M_YE
    s_waitcnt lgkmcnt(0)
    s_barrier
    s_add_u32 m0, s35, 0
    v_and_or_b32 v108, v108, s37, v199
    buffer_load_dwordx4 v108, s[8:11], 0 offen lds
    s_add_u32 m0, s35, 1024
    v_and_or_b32 v109, v109, s37, v200
    buffer_load_dwordx4 v109, s[8:11], 0 offen lds
    s_add_u32 m0, s35, 2048
    v_and_or_b32 v110, v110, s37, v199
    buffer_load_dwordx4 v110, s[8:11], 0 offen lds
    s_add_u32 m0, s35, 3072
    v_and_or_b32 v111, v111, s37, v200
    buffer_load_dwordx4 v111, s[8:11], 0 offen lds
    s_add_u32 m0, s36, 0
    v_add_u32 v112, v112, v201
    buffer_load_dwordx4 v112, s[12:15], 0 offen lds
    s_branch M_W0
M_YE:
    s_waitcnt lgkmcnt(0)
    s_barrier
    s_branch M_BDONE2
M_YNG2:
    s_cmp_lt_u32 s30, 2
    s_cbranch_scc1 M_GO
    s_add_u32 m0, s35, 4096
    s_nop 0
    buffer_load_dwordx4 v124, s[8:11], 0 offen lds
    s_add_u32 m0, s35, 5120
    s_nop 0
    buffer_load_dwordx4 v125, s[8:11], 0 offen lds
    s_add_u32 m0, s35, 6144
    s_nop 0
    buffer_load_dwordx4 v126, s[8:11], 0 offen lds
    s_add_u32 m0, s35, 7168
    s_nop 0
    buffer_load_dwordx4 v127, s[8:11], 0 offen lds
    s_add_u32 m0, s36, 1024
    s_nop 0
    buffer_load_dwordx4 v128, s[12:15], 0 offen lds
    s_branch M_GO
M_RA:
    v_cmp_lt_i32 s[68:69], 32, v212
    v_cmp_lt_i32 s[70:71], 33, v212
    v_cmp_lt_i32 s[72:73], 34, v212
    v_cmp_lt_i32 s[74:75], 35, v212
    v_and_b32_sdwa v132, v219, v92 dst_sel:DWORD dst_unused:UNUSED_PAD src0_sel:DWORD src1_sel:BYTE_3
    v_and_b32_sdwa v133, v219, v93 dst_sel:DWORD dst_unused:UNUSED_PAD src0_sel:DWORD src1_sel:BYTE_3
    v_and_b32_sdwa v134, v219, v94 dst_sel:DWORD dst_unused:UNUSED_PAD src0_sel:DWORD src1_sel:BYTE_3
    v_and_b32_sdwa v135, v219, v95 dst_sel:DWORD dst_unused:UNUSED_PAD src0_sel:DWORD src1_sel:BYTE_3
    s_mov_b64 exec, s[68:69]
    ds_add_rtn_u32 v112, v132, v214
    s_mov_b64 exec, s[70:71]
    ds_add_rtn_u32 v113, v133, v214
    s_mov_b64 exec, s[72:73]
    ds_add_rtn_u32 v114, v134, v214
    s_mov_b64 exec, s[74:75]
    ds_add_rtn_u32 v115, v135, v214
    s_mov_b64 exec, -1
    v_bfe_u32 v184, v92, 14, 12
    v_lshl_add_u32 v184, v184, 5, v213
    v_alignbit_b32 v92, v92, v92, 25
    v_bfe_u32 v185, v93, 14, 12
    v_lshl_add_u32 v185, v185, 5, v213
    v_alignbit_b32 v93, v93, v93, 25
    v_bfe_u32 v186, v94, 14, 12
    v_lshl_add_u32 v186, v186, 5, v213
    v_alignbit_b32 v94, v94, v94, 25
    v_bfe_u32 v187, v95, 14, 12
    v_lshl_add_u32 v187, v187, 5, v213
    v_alignbit_b32 v95, v95, v95, 25
    s_branch M_RAR
M_RB:
    s_mov_b64 exec, s[68:69]
    ds_read_b32 v132, v132 offset:512
    s_mov_b64 exec, s[70:71]
    ds_read_b32 v133, v133 offset:512
    s_mov_b64 exec, s[72:73]
    ds_read_b32 v134, v134 offset:512
    s_mov_b64 exec, s[74:75]
    ds_read_b32 v135, v135 offset:512
    s_mov_b64 exec, -1
    s_waitcnt lgkmcnt(0)
    v_add_lshl_u32 v112, v112, v132, 2
    v_add_lshl_u32 v113, v113, v133, 2
    v_add_lshl_u32 v114, v114, v134, 2
    v_add_lshl_u32 v115, v115, v135, 2
    s_mov_b64 exec, s[68:69]
    ds_write2st64_b32 v112, v92, v184 offset1:64
    s_mov_b64 exec, s[70:71]
    ds_write2st64_b32 v113, v93, v185 offset1:64
    s_mov_b64 exec, s[72:73]
    ds_write2st64_b32 v114, v94, v186 offset1:64
    s_mov_b64 exec, s[74:75]
    ds_write2st64_b32 v115, v95, v187 offset1:64
    s_mov_b64 exec, -1
    v_cmp_lt_i32 s[68:69], 0, v212
    v_cmp_lt_i32 s[70:71], 1, v212
    v_cmp_lt_i32 s[72:73], 2, v212
    v_cmp_lt_i32 s[74:75], 3, v212
    s_branch M_RBR
M_SLOW:
    s_mov_b32 s40, 1
    s_mov_b32 s41, -1
M_SNEXT:
    s_add_u32 s41, s41, 1
    s_cmp_ge_u32 s41, 250
    s_cbranch_scc1 M_EPI
    s_lshl_b32 s38, s41, 6
    s_load_dword s34, s[48:49], s38
    s_waitcnt lgkmcnt(0)
    s_lshr_b32 s39, s34, 16
    s_cmp_eq_u32 s39, 0
    s_cbranch_scc1 M_SNEXT
    s_barrier
    v_and_b32 v210, 127, v0
    v_lshlrev_b32 v210, 2, v210
    v_mov_b32 v211, 0
    ds_write_b32 v210, v211
    s_and_b32 s34, s34, 0xffff
    s_mul_i32 s38, s41, 3200
    s_add_u32 s34, s34, s38
    v_add_u32 v209, s34, v0
    v_mov_b32 v210, s38
    v_lshlrev_b32 v213, 5, v210
    v_lshlrev_b32 v209, 2, v209
    v_sub_u32 v212, s39, v0
    v_add_u32 v212, 511, v212
    v_ashrrev_i32 v212, 9, v212
    v_cmp_lt_i32 vcc, 4, v212
    v_add_u32 v210, 4, v212
    v_mov_b32 v219, 0xfc
    v_cndmask_b32 v212, v212, v210, vcc
    buffer_load_dword v76, v209, s[16:19], 0 offen
    v_add_u32 v209, 2048, v209
    buffer_load_dword v77, v209, s[16:19], 0 offen
    v_add_u32 v209, 2048, v209
    buffer_load_dword v78, v209, s[16:19], 0 offen
    v_add_u32 v209, 2048, v209
    buffer_load_dword v79, v209, s[16:19], 0 offen
    v_add_u32 v209, 2048, v209
    buffer_load_dword v80, v209, s[16:19], 0 offen
    v_add_u32 v209, 2048, v209
    buffer_load_dword v81, v209, s[16:19], 0 offen
    v_add_u32 v209, 2048, v209
    buffer_load_dword v82, v209, s[16:19], 0 offen
    v_cmp_lt_i32 s[68:69], 0, v212
    v_cmp_lt_i32 s[70:71], 1, v212
    v_cmp_lt_i32 s[72:73], 2, v212
    v_cmp_lt_i32 s[74:75], 3, v212
    v_cmp_lt_i32 s[76:77], 8, v212
    v_cmp_lt_i32 s[78:79], 9, v212
    v_cmp_lt_i32 s[80:81], 10, v212
    v_cmp_lt_i32 s[82:83], 11, v212
    v_cmp_lt_i32 s[84:85], 16, v212
    v_cmp_lt_i32 s[86:87], 17, v212
    v_cmp_lt_i32 s[88:89], 18, v212
    v_cmp_lt_i32 s[90:91], 19, v212
    s_waitcnt vmcnt(0) lgkmcnt(0)
    s_barrier
    v_and_b32_sdwa v116, v219, v76 dst_sel:DWORD dst_unused:UNUSED_PAD src0_sel:DWORD src1_sel:BYTE_3
    v_and_b32_sdwa v117, v219, v77 dst_sel:DWORD dst_unused:UNUSED_PAD src0_sel:DWORD src1_sel:BYTE_3
    v_and_b32_sdwa v118, v219, v78 dst_sel:DWORD dst_unused:UNUSED_PAD src0_sel:DWORD src1_sel:BYTE_3
    v_and_b32_sdwa v119, v219, v79 dst_sel:DWORD dst_unused:UNUSED_PAD src0_sel:DWORD src1_sel:BYTE_3
    v_and_b32_sdwa v120, v219, v80 dst_sel:DWORD dst_unused:UNUSED_PAD src0_sel:DWORD src1_sel:BYTE_3
    v_and_b32_sdwa v121, v219, v81 dst_sel:DWORD dst_unused:UNUSED_PAD src0_sel:DWORD src1_sel:BYTE_3
    v_and_b32_sdwa v122, v219, v82 dst_sel:DWORD dst_unused:UNUSED_PAD src0_sel:DWORD src1_sel:BYTE_3
    s_mov_b64 exec, s[68:69]
    ds_add_rtn_u32 v96, v116, v214
    s_mov_b64 exec, s[70:71]
    ds_add_rtn_u32 v97, v117, v214
    s_mov_b64 exec, s[72:73]
    ds_add_rtn_u32 v98, v118, v214
    s_mov_b64 exec, s[74:75]
    ds_add_rtn_u32 v99, v119, v214
    s_mov_b64 exec, s[76:77]
    ds_add_rtn_u32 v100, v120, v214
    s_mov_b64 exec, s[78:79]
    ds_add_rtn_u32 v101, v121, v214
    s_mov_b64 exec, s[80:81]
    ds_add_rtn_u32 v102, v122, v214
    s_mov_b64 exec, -1
    v_bfe_u32 v220, v76, 14, 12
    v_lshl_add_u32 v220, v220, 5, v213
    v_alignbit_b32 v76, v76, v76, 25
    v_bfe_u32 v221, v77, 14, 12
    v_lshl_add_u32 v221, v221, 5, v213
    v_alignbit_b32 v77, v77, v77, 25
    v_bfe_u32 v222, v78, 14, 12
    v_lshl_add_u32 v222, v222, 5, v213
    v_alignbit_b32 v78, v78, v78, 25
    v_bfe_u32 v223, v79, 14, 12
    v_lshl_add_u32 v223, v223, 5, v213
    v_alignbit_b32 v79, v79, v79, 25
    v_bfe_u32 v224, v80, 14, 12
    v_lshl_add_u32 v224, v224, 5, v213
    v_alignbit_b32 v80, v80, v80, 25
    v_bfe_u32 v225, v81, 14, 12
    v_lshl_add_u32 v225, v225, 5, v213
    v_alignbit_b32 v81, v81, v81, 25
    v_bfe_u32 v226, v82, 14, 12
    v_lshl_add_u32 v226, v226, 5, v213
    v_alignbit_b32 v82, v82, v82, 25
    s_waitcnt lgkmcnt(0)
    s_barrier
    v_lshlrev_b32 v209, 2, v2
    ds_read_b32 v210, v209
    v_mov_b32 v211, 256
    ds_read_b32 v192, v211
    s_waitcnt lgkmcnt(0)
    v_add_u32 v194, s28, v210
    v_add_u32 v210, 7, v210
    v_and_b32 v210, -8, v210
    v_readfirstlane_b32 s39, v192
    v_mov_b32 v211, v210
    s_nop 1
    v_add_u32_dpp v211, v211, v211 row_shr:1 row_mask:0xf bank_mask:0xf bound_ctrl:1
    s_nop 1
    v_add_u32_dpp v211, v211, v211 row_shr:2 row_mask:0xf bank_mask:0xf bound_ctrl:1
    s_nop 1
    v_add_u32_dpp v211, v211, v211 row_shr:4 row_mask:0xf bank_mask:0xf bound_ctrl:1
    s_nop 1
    v_add_u32_dpp v211, v211, v211 row_shr:8 row_mask:0xf bank_mask:0xf bound_ctrl:1
    s_nop 1
    v_add_u32_dpp v211, v211, v211 row_bcast:15 row_mask:0xa bank_mask:0xf
    s_nop 1
    v_add_u32_dpp v211, v211, v211 row_bcast:31 row_mask:0xc bank_mask:0xf
    v_sub_u32 v210, v211, v210
    v_readlane_b32 s38, v211, 63
    v_add_u32 v195, 20736, v210
    ds_write_b32 v209, v195 offset:512
    s_mov_b32 s51, 0
    s_branch M_BATCH
M_CODE_END:
.section .rodata,"a"
.p2align 6
.amdhsa_kernel part_kernel
  .amdhsa_next_free_vgpr 76
  .amdhsa_next_free_sgpr 80
  .amdhsa_accum_offset 76
  .amdhsa_group_segment_fixed_size 0
  .amdhsa_kernarg_size 80
  .amdhsa_user_sgpr_count 2
  .amdhsa_user_sgpr_kernarg_segment_ptr 1
  .amdhsa_system_sgpr_workgroup_id_x 1
.end_amdhsa_kernel
.p2align 6
.amdhsa_kernel gather_scatter__edge_featured_mpnn_egc__graph_kernel
  .amdhsa_next_free_vgpr 240
  .amdhsa_next_free_sgpr 102
  .amdhsa_accum_offset 240
  .amdhsa_group_segment_fixed_size 0
  .amdhsa_kernarg_size 80
  .amdhsa_user_sgpr_count 2
  .amdhsa_user_sgpr_kernarg_segment_ptr 1
  .amdhsa_system_sgpr_workgroup_id_x 1
.end_amdhsa_kernel
```
